```python
import torch

def _softmax(x, axis=-1):
    return torch.softmax(x, dim=axis)
def _gelu(x):
    return torch.nn.functional.gelu(x, approximate="tanh")
def _silu(x):
    return torch.nn.functional.silu(x)
def _sigmoid(x):
    return torch.sigmoid(x)
def _layernorm(x, axis=-1, eps=1e-5):
    m = x.mean(dim=axis, keepdim=True)
    v = x.var(dim=axis, keepdim=True, unbiased=False)
    return (x - m) / torch.sqrt(v + eps)
def _scatter_add(tgt, idx, src, axis=0):
    return tgt.clone().index_add_(axis, idx, src)
def _segment_sum(src, seg, n):
    out = torch.zeros((n,) + src.shape[1:], dtype=src.dtype)
    return out.index_add_(0, seg, src)
def _pad(x, pw):
    flat = tuple(v for pair in reversed(pw) for v in pair)
    return torch.nn.functional.pad(x, flat)

kernel_name = 'concat_heads__softmax_full_mha__linear_kernel_hedgehog__prompt'

def setup_inputs():

    _w = (lambda a: (lambda t: t.to(torch.bfloat16) if t.is_floating_point() else t)(torch.as_tensor(a)))
    def _A_setup():
        B, S, D = 1, 2048, 448
        return {
            "x": _w((lambda *s: torch.randn(*s, dtype=torch.bfloat16) * 0.4)(B, S, D)),
            "wqkv": _w((lambda *s: torch.randn(*s, dtype=torch.bfloat16) * 0.4)(D, 3 * D)),
            "wo": _w((lambda *s: torch.randn(*s, dtype=torch.bfloat16) * 0.05)(D, D)),
        }
    _A_in = _A_setup()

    def _B_setup():
        B, S, D, H = 1, 2048, 448, 16
        Dh = D // H
        return {
            "x": _w((lambda *s: torch.randn(*s, dtype=torch.bfloat16) * 0.8)(B, S, D)),
            "wqkv": _w((lambda *s: torch.randn(*s, dtype=torch.bfloat16) * 1.6)(D, 3 * D)),
            "w_phi": _w((lambda *s: torch.randn(*s, dtype=torch.bfloat16) * 1.6)(H, Dh, Dh) * (Dh ** -0.5)),
            "wo": _w((lambda *s: torch.randn(*s, dtype=torch.bfloat16) * 0.1)(D, D)),
        }
    _B_in = _B_setup()

    return {
        "A_x": _A_in["x"],
        "A_wqkv": _A_in["wqkv"],
        "A_wo": _A_in["wo"],
        "B_x": _B_in["x"],
        "B_wqkv": _B_in["wqkv"],
        "B_w_phi": _B_in["w_phi"],
        "B_wo": _B_in["wo"],
    }

def reference(A_x, A_wqkv, A_wo, B_x, B_wqkv, B_w_phi, B_wo):
    def _A_ref(x, wqkv, wo):
        B, S, D = x.shape
        H = 16; Dh = D // H
        qkv = (lambda x, *d: x.permute(*d))((x @ wqkv).reshape(B, S, 3, H, Dh), 2, 0, 3, 1, 4)
        q, k, v = qkv[0], qkv[1], qkv[2]
        scale = Dh ** -0.5
        scores = torch.einsum("bhqd,bhkd->bhqk", q, k) * scale
        p = _softmax(scores, axis=-1)
        o = torch.einsum("bhqk,bhkd->bhqd", p, v)
        return (lambda x, *d: x.permute(*d))(o, 0, 2, 1, 3).reshape(B, S, D) @ wo

    def _B_ref(x, wqkv, w_phi, wo):
        B, S, D = x.shape
        H = 16; Dh = D // H
        qkv = (lambda x, *d: x.permute(*d))((x @ wqkv).reshape(B, S, 3, H, Dh), 2, 0, 3, 1, 4)
        q, k, v = qkv[0], qkv[1], qkv[2]
        pq = torch.einsum("bhsd,hdf->bhsf", q, w_phi)
        pk = torch.einsum("bhsd,hdf->bhsf", k, w_phi)
        phi_q = torch.concatenate([_softmax(pq, axis=-1), _softmax(-pq, axis=-1)], axis=-1)
        phi_k = torch.concatenate([_softmax(pk, axis=-1), _softmax(-pk, axis=-1)], axis=-1)
        kv = torch.einsum("bhsf,bhsd->bhfd", phi_k, v)
        z  = torch.einsum("bhsf->bhf", phi_k)
        num = torch.einsum("bhqf,bhfd->bhqd", phi_q, kv)
        den = torch.einsum("bhqf,bhf->bhq", phi_q, z)[..., None] + 1e-6
        o = num / den
        return (lambda x, *d: x.permute(*d))(o, 0, 2, 1, 3).reshape(B, S, D) @ wo

    a = _A_ref(A_x, A_wqkv, A_wo)
    b = _B_ref(B_x, B_wqkv, B_w_phi, B_wo)
    return torch.concatenate([a, b], axis=-1)
```

```asm
; @launch grid=(256,1,1) block=(512,1,1) lds=163840
.amdgcn_target "amdgcn-amd-amdhsa--gfx950"
.text
.globl concat_heads__softmax_full_mha__linear_kernel_hedgehog__prompt_kernel
.p2align 12
.p2align 8
.type concat_heads__softmax_full_mha__linear_kernel_hedgehog__prompt_kernel,@function
concat_heads__softmax_full_mha__linear_kernel_hedgehog__prompt_kernel:
    s_cmp_ge_u32 s2, 256
    s_cbranch_scc1 L_end
    s_load_dwordx16 s[4:19], s[0:1], 0
    s_load_dwordx4 s[20:23], s[0:1], 64
    s_getpc_b64 s[60:61]
L_pc:
    s_lshr_b32 s54, s2, 3
    s_lshl_b32 s62, s54, 11
    s_min_u32 s62, s62, L_end-L_pc-2048
    v_lshl_add_u32 v5, v0, 2, s62
    v_lshrrev_b32 v4, 6, v0
    global_load_dword v240, v5, s[60:61]
    v_readfirstlane_b32 s52, v4
    v_and_b32 v1, 63, v0
    s_and_b32 s53, s2, 7
    s_lshr_b32 s55, s54, 4
    s_and_b32 s60, s53, 6
    s_lshl_b32 s60, s60, 1
    s_and_b32 s56, s54, 3
    s_add_u32 s56, s56, s60
    s_andn2_b32 s60, 1, s53
    s_cselect_b32 s100, 7, 4
    s_lshl_b32 s60, s60, 2
    s_lshr_b32 s61, s54, 2
    s_xor_b32 s100, s100, s61
    s_and_b32 s57, s61, 3
    s_add_u32 s57, s57, s60
    s_cmp_lt_u32 s52, 4
    s_cbranch_scc1 L_comp
    s_setprio 3
    s_and_b32 s80, s52, 3
    v_lshrrev_b32 v4, 3, v1
    v_and_b32 v9, 7, v1
    v_lshrrev_b32 v6, 4, v1
    v_mul_u32_u24 v5, 56, v4
    v_xor_b32 v6, v6, v9
    v_add_lshl_u32 v16, v6, v5, 4
    s_xor_b32 s93, s57, s56
    s_lshr_b32 s93, s93, 1
    s_and_b32 s93, s93, 1
    s_mov_b32 s73, s93
    s_lshl_b32 s61, s80, 1
    s_and_b32 s60, s57, 1
    s_cselect_b32 s67, -1, 1
    s_add_u32 s64, s61, s60
    s_lshl_b32 s74, s56, 3
    s_add_u32 s74, s74, s64
    s_mulk_i32 s74, 14336
    s_lshl_b32 s64, s64, 11
    s_mulk_i32 s67, 14336
    v_xor_b32 v17, 64, v16
    v_add_u32 v17, 6144, v17
    v_bfrev_b32 v7, v4
    v_bfe_u32 v7, v7, 28, 3
    v_xor_b32 v7, v7, v9
    v_and_b32 v5, 4, v4
    v_add_u32 v4, v4, v5
    v_mul_u32_u24 v4, 0xa8, v4
    v_add_lshl_u32 v18, v4, v7, 4
    v_add_u32 v7, 1, v7
    v_and_b32 v7, 8, v7
    v_lshl_add_u32 v18, v7, 27, v18
    s_and_b32 s60, s56, 1
    s_cselect_b32 s68, -1, 1
    s_add_u32 s65, s61, s60
    s_add_u32 s75, s65, s61
    s_mulk_i32 s75, 10752
    s_add_u32 s66, s65, s68
    s_mulk_i32 s68, 10752
    s_mulk_i32 s65, 3072
    s_mulk_i32 s66, 3072
    s_addk_i32 s65, 16384
    s_addk_i32 s66, 16384
    s_mov_b32 s71, 0
    s_mov_b32 s70, 0
    s_mov_b32 s26, 1835008
    s_mov_b32 s27, 0x20000
    s_mov_b32 s30, 1204224
    s_mov_b32 s31, s27
    s_cmp_eq_u32 s55, 0
    s_cselect_b32 s60, 3, 1
    s_cselect_b32 s69, 1, 8
    s_mul_i32 s60, s60, s57
    s_mulk_i32 s69, 112
    s_mulk_i32 s60, 112
    s_waitcnt lgkmcnt(0)
    s_cselect_b64 s[24:25], s[4:5], s[10:11]
    s_cselect_b64 s[28:29], s[6:7], s[12:13]
    s_add_u32 s75, s75, s60
    s_cmp_eq_u32 s100, 0
    s_cbranch_scc1 L_zero
L_ld:
    s_lshl_b32 s76, s73, 7
    s_add_u32 m0, s71, s64
    s_add_u32 s76, s76, s74
    buffer_load_dwordx4 v16, s[24:27], s76 offen lds
    buffer_load_dwordx4 v17, s[24:27], s76 offen offset:1024 lds
    s_mul_i32 s77, s73, 172032
    s_xor_b32 s60, m0, 2048
    s_add_u32 m0, s71, s65
    s_add_u32 s77, s77, s75
    buffer_load_dwordx4 v18, s[28:31], s77 offen lds
    s_addk_i32 m0, 1024
    s_add_u32 s61, s77, s69
    buffer_load_dwordx4 v18, s[28:31], s61 offen lds
    s_addk_i32 m0, 1024
    s_add_u32 s61, s61, s69
    buffer_load_dwordx4 v18, s[28:31], s61 offen lds
    s_mov_b32 m0, s60
    s_add_u32 s76, s76, s67
    buffer_load_dwordx4 v16, s[24:27], s76 offen lds
    buffer_load_dwordx4 v17, s[24:27], s76 offen offset:1024 lds
    s_add_u32 m0, s71, s66
    s_add_u32 s77, s77, s68
    s_cmp_eq_u32 s70, 0
    s_cbranch_scc1 L_ldb
    s_waitcnt vmcnt(7)
    s_barrier
L_ldb:
    buffer_load_dwordx4 v18, s[28:31], s77 offen lds
    s_addk_i32 m0, 1024
    s_add_u32 s61, s77, s69
    buffer_load_dwordx4 v18, s[28:31], s61 offen lds
    s_addk_i32 m0, 1024
    s_add_u32 s61, s61, s69
    buffer_load_dwordx4 v18, s[28:31], s61 offen lds
    s_add_u32 s71, s71, 40960
    s_cmp_eq_u32 s71, 122880
    s_cselect_b32 s71, 0, s71
    s_add_u32 s70, s70, 1
    s_xor_b32 s73, s70, s93
    s_min_u32 s73, s73, 6
    s_cmp_lt_u32 s70, 7
    s_cbranch_scc1 L_ld
    s_branch L_ld1
L_zero:
    s_mov_b32 s32, s22
    s_mov_b32 s33, s23
    s_mov_b32 s34, 16777216
    s_mov_b32 s35, 0x20000
    s_lshl_b32 s60, s53, 14
    s_and_b32 s61, s54, 3
    s_lshl_b32 s61, s61, 2
    s_add_u32 s61, s61, s80
    s_lshl_b32 s61, s61, 10
    s_add_u32 s60, s60, s61
    s_add_u32 s60, s60, 14680064
    v_lshlrev_b32 v2, 4, v1
    v_mov_b32 v4, 0
    v_mov_b32 v5, 0
    v_mov_b32 v6, 0
    v_mov_b32 v7, 0
    buffer_store_dwordx4 v[4:7], v2, s[32:35], s60 offen sc1
    s_branch L_ld
L_comp:
    s_and_b32 s93, s52, 1
    s_lshr_b32 s3, s52, 1
    s_mov_b32 s88, 0x10001000
    s_mov_b32 s89, 0x10001000
    s_waitcnt lgkmcnt(0)
    s_mov_b32 s32, s22
    s_mov_b32 s33, s23
    s_mov_b32 s34, 16777216
    s_mov_b32 s35, 0x20000
    s_mov_b32 s36, s20
    s_mov_b32 s37, s21
    s_mov_b32 s38, 256
    s_mov_b32 s39, 0x20000
    s_mov_b32 s40, s14
    s_mov_b32 s41, s15
    s_mov_b32 s42, 25088
    s_mov_b32 s43, 0x20000
    s_mov_b32 s48, s18
    s_mov_b32 s49, s19
    s_mov_b32 s50, 3670016
    s_mov_b32 s51, 0x20000
    s_mov_b32 s78, 0x3fb8aa3b
    s_mov_b32 s79, 0x3fb8aa3b
    s_mov_b32 s86, 0
    s_mov_b32 s87, -1
    s_lshr_b32 s58, s54, 4
    s_lshl_b32 s60, s53, 1
    s_add_u32 s58, s58, s60
    s_and_b32 s59, s54, 15
    s_and_b32 s80, s52, 3
    s_lshr_b32 s81, s52, 2
    s_mul_i32 s72, s53, 12288
    s_add_u32 s72, s72, 14680064
    s_mul_i32 s60, s54, 37
    s_lshr_b32 s60, s60, 8
    s_mul_i32 s61, s60, 7
    s_sub_u32 s83, s54, s61
    s_lshl_b32 s85, s53, 2
    s_add_u32 s85, s85, s60
    v_lshlrev_b32 v2, 4, v1
    v_lshrrev_b32 v3, 5, v1
    v_lshlrev_b32 v12, 7, v1
    v_mov_b32 v13, 1
    v_and_b32 v241, 3, v1
    v_lshlrev_b32 v241, 2, v241
    v_add_u32 v241, 161792, v241
    s_lshl_b32 s60, s80, 2
    s_add_u32 s60, s60, 161792
    v_mov_b32 v242, s60
    v_mov_b32 v4, 0
    v_and_b32 v5, 0x7f, v0
    v_lshlrev_b32 v5, 2, v5
    v_add_u32 v5, 161792, v5
    ds_write_b32 v5, v4
    v_and_b32 v4, 15, v1
    v_lshrrev_b32 v8, 4, v1
    v_bfe_u32 v5, v1, 1, 3
    v_xor_b32 v5, v5, v8
    v_lshlrev_b32 v5, 4, v5
    s_lshl_b32 s60, s93, 6
    v_add_u32 v4, s60, v4
    v_lshl_add_u32 v16, v4, 7, v5
    v_xor_b32 v17, 64, v16
    v_bfe_u32 v4, v1, 2, 3
    v_mul_u32_u24 v5, 48, v3
    v_add_lshl_u32 v5, v5, v4, 7
    v_and_b32 v6, 8, v1
    v_and_b32 v4, 4, v4
    v_or_b32 v4, v4, v6
    v_and_b32 v6, 3, v1
    v_add_u32 v9, 5, v6
    v_and_b32 v9, 8, v9
    s_mul_i32 s60, s3, 3
    s_add_u32 s60, s60, 0
    s_add_u32 s61, s3, 0
    s_cmp_eq_u32 s55, 0
    s_cselect_b32 s60, s60, s61
    s_and_b32 s61, s60, 1
    s_lshr_b32 s60, s60, 1
    s_lshl_b32 s60, s60, 10
    s_add_u32 s60, s60, 16384
    s_xor_b32 s62, s61, 1
    s_mul_i32 s61, s61, 7
    v_add_u32 v10, s60, v5
    v_add_u32 v7, s61, v6
    v_mad_u32_u24 v8, v9, s62, v7
    v_add_u32 v8, 4, v8
    v_xor_b32 v7, v7, v4
    v_xor_b32 v8, v8, v4
    v_lshl_add_u32 v18, v7, 3, v10
    v_lshl_add_u32 v19, v8, 3, v10
    s_mul_i32 s60, s3, 3
    s_add_u32 s60, s60, 1
    s_add_u32 s61, s3, 2
    s_cmp_eq_u32 s55, 0
    s_cselect_b32 s60, s60, s61
    s_and_b32 s61, s60, 1
    s_lshr_b32 s60, s60, 1
    s_lshl_b32 s60, s60, 10
    s_add_u32 s60, s60, 16384
    s_xor_b32 s62, s61, 1
    s_mul_i32 s61, s61, 7
    v_add_u32 v10, s60, v5
    v_add_u32 v7, s61, v6
    v_mad_u32_u24 v8, v9, s62, v7
    v_add_u32 v8, 4, v8
    v_xor_b32 v7, v7, v4
    v_xor_b32 v8, v8, v4
    v_lshl_add_u32 v20, v7, 3, v10
    v_lshl_add_u32 v21, v8, 3, v10
    s_mul_i32 s60, s3, 3
    s_add_u32 s60, s60, 2
    s_add_u32 s61, s3, 4
    s_cmp_eq_u32 s55, 0
    s_cselect_b32 s60, s60, s61
    s_and_b32 s61, s60, 1
    s_lshr_b32 s60, s60, 1
    s_lshl_b32 s60, s60, 10
    s_add_u32 s60, s60, 16384
    s_xor_b32 s62, s61, 1
    s_mul_i32 s61, s61, 7
    v_add_u32 v10, s60, v5
    v_add_u32 v7, s61, v6
    v_mad_u32_u24 v8, v9, s62, v7
    v_add_u32 v8, 4, v8
    v_xor_b32 v7, v7, v4
    v_xor_b32 v8, v8, v4
    v_lshl_add_u32 v22, v7, 3, v10
    v_lshl_add_u32 v23, v8, 3, v10
    s_lshl_b32 s68, s57, 1
    s_add_u32 s68, s68, s3
    s_mul_i32 s60, s68, 3
    s_add_u32 s60, s60, 0
    s_lshr_b32 s60, s60, 4
    s_cmp_eq_u32 s55, 0
    s_cselect_b32 s60, s60, 0
    v_mov_b32 v4, 0
    v_mov_b32 v5, 0
    s_cmp_eq_u32 s60, 2
    s_cselect_b64 exec, s[88:89], 0
    v_mov_b32 v4, 1.0
    s_cmp_eq_u32 s60, 1
    s_cselect_b32 exec_hi, 0xffff0000, 0
    s_mov_b32 exec_lo, 0
    v_mov_b32 v5, 1.0
    s_mov_b64 exec, -1
    v_or_b32 v6, v4, v5
    v_mov_b32 v64, 0
    v_mov_b32 v65, 0
    v_mov_b32 v66, 0
    v_mov_b32 v67, 0
    v_mov_b32 v68, v5
    v_mov_b32 v69, v5
    v_mov_b32 v70, v5
    v_mov_b32 v71, 0
    v_mov_b32 v72, v4
    v_mov_b32 v73, v4
    v_mov_b32 v74, v4
    v_mov_b32 v75, v4
    v_mov_b32 v76, v6
    v_mov_b32 v77, v6
    v_mov_b32 v78, v6
    v_mov_b32 v79, v4
    v_mov_b32 v80, 0
    v_mov_b32 v81, 0
    v_mov_b32 v82, 0
    v_mov_b32 v83, 0
    v_mov_b32 v84, v5
    v_mov_b32 v85, v5
    v_mov_b32 v86, v5
    v_mov_b32 v87, 0
    v_mov_b32 v88, v4
    v_mov_b32 v89, v4
    v_mov_b32 v90, v4
    v_mov_b32 v91, v4
    v_mov_b32 v92, v6
    v_mov_b32 v93, v6
    v_mov_b32 v94, v6
    v_mov_b32 v95, v4
    s_mul_i32 s60, s68, 3
    s_add_u32 s60, s60, 1
    s_lshr_b32 s60, s60, 4
    s_cmp_eq_u32 s55, 0
    s_cselect_b32 s60, s60, 0
    v_mov_b32 v4, 0
    v_mov_b32 v5, 0
    s_cmp_eq_u32 s60, 2
    s_cselect_b64 exec, s[88:89], 0
    v_mov_b32 v4, 1.0
    s_cmp_eq_u32 s60, 1
    s_cselect_b32 exec_hi, 0xffff0000, 0
    s_mov_b32 exec_lo, 0
    v_mov_b32 v5, 1.0
    s_mov_b64 exec, -1
    v_or_b32 v6, v4, v5
    v_mov_b32 v96, 0
    v_mov_b32 v97, 0
    v_mov_b32 v98, 0
    v_mov_b32 v99, 0
    v_mov_b32 v100, v5
    v_mov_b32 v101, v5
    v_mov_b32 v102, v5
    v_mov_b32 v103, 0
    v_mov_b32 v104, v4
    v_mov_b32 v105, v4
    v_mov_b32 v106, v4
    v_mov_b32 v107, v4
    v_mov_b32 v108, v6
    v_mov_b32 v109, v6
    v_mov_b32 v110, v6
    v_mov_b32 v111, v4
    v_mov_b32 v112, 0
    v_mov_b32 v113, 0
    v_mov_b32 v114, 0
    v_mov_b32 v115, 0
    v_mov_b32 v116, v5
    v_mov_b32 v117, v5
    v_mov_b32 v118, v5
    v_mov_b32 v119, 0
    v_mov_b32 v120, v4
    v_mov_b32 v121, v4
    v_mov_b32 v122, v4
    v_mov_b32 v123, v4
    v_mov_b32 v124, v6
    v_mov_b32 v125, v6
    v_mov_b32 v126, v6
    v_mov_b32 v127, v4
    s_mul_i32 s60, s68, 3
    s_add_u32 s60, s60, 2
    s_lshr_b32 s60, s60, 4
    s_cmp_eq_u32 s55, 0
    s_cselect_b32 s60, s60, 2
    v_mov_b32 v4, 0
    v_mov_b32 v5, 0
    s_cmp_eq_u32 s60, 2
    s_cselect_b64 exec, s[88:89], 0
    v_mov_b32 v4, 1.0
    s_cmp_eq_u32 s60, 1
    s_cselect_b32 exec_hi, 0xffff0000, 0
    s_mov_b32 exec_lo, 0
    v_mov_b32 v5, 1.0
    s_mov_b64 exec, -1
    v_or_b32 v6, v4, v5
    v_mov_b32 v128, 0
    v_mov_b32 v129, 0
    v_mov_b32 v130, 0
    v_mov_b32 v131, 0
    v_mov_b32 v132, v5
    v_mov_b32 v133, v5
    v_mov_b32 v134, v5
    v_mov_b32 v135, 0
    v_mov_b32 v136, v4
    v_mov_b32 v137, v4
    v_mov_b32 v138, v4
    v_mov_b32 v139, v4
    v_mov_b32 v140, v6
    v_mov_b32 v141, v6
    v_mov_b32 v142, v6
    v_mov_b32 v143, v4
    v_mov_b32 v144, 0
    v_mov_b32 v145, 0
    v_mov_b32 v146, 0
    v_mov_b32 v147, 0
    v_mov_b32 v148, v5
    v_mov_b32 v149, v5
    v_mov_b32 v150, v5
    v_mov_b32 v151, 0
    v_mov_b32 v152, v4
    v_mov_b32 v153, v4
    v_mov_b32 v154, v4
    v_mov_b32 v155, v4
    v_mov_b32 v156, v6
    v_mov_b32 v157, v6
    v_mov_b32 v158, v6
    v_mov_b32 v159, v4
    s_lshl_b32 s73, s93, 1
    s_add_u32 s73, s73, s3
    v_bfe_u32 v4, v1, 4, 1
    v_and_b32 v14, 15, v1
    v_lshlrev_b32 v14, 4, v14
    v_lshl_add_u32 v14, v4, 10, v14
    v_lshl_add_u32 v14, v3, 8, v14
    s_lshl_b32 s60, s59, 2
    s_add_u32 s60, s60, s73
    s_lshl_b32 s30, s60, 4
    s_and_b32 s31, s53, 6
    s_add_u32 s30, s30, s31
    s_and_b32 s31, s58, 1
    s_add_u32 s30, s30, s31
    s_and_b32 s31, s53, 1
    s_lshl_b32 s31, s31, 3
    s_add_u32 s30, s30, s31
    s_lshl_b32 s30, s30, 11
    s_lshl_b32 s31, s60, 9
    s_add_u32 s30, s30, 10485760
    s_add_u32 s31, s31, 14778368
    s_lshl_b32 s64, s56, 1
    s_add_u32 s64, s64, s93
    s_lshl_b32 s64, s64, 1
    v_and_b32 v206, 15, v1
    v_lshlrev_b32 v206, 4, v206
    v_bfe_u32 v4, v1, 4, 1
    v_lshl_add_u32 v206, v4, 10, v206
    v_lshl_add_u32 v206, v3, 9, v206
    s_mov_b32 s70, 0
    s_mov_b32 s71, 0
    s_mov_b32 s66, 40960
    s_mov_b32 s67, 4294885376
    s_mov_b32 s65, s66
    s_cmp_eq_u32 s55, 0
    s_cbranch_scc0 L_p1_B
    s_mul_i32 s60, s68, 3
    s_add_u32 s60, s60, 0
    s_and_b32 s61, s60, 15
    s_lshl_b32 s61, s61, 6
    s_add_u32 s61, s61, s64
    s_lshr_b32 s60, s60, 4
    s_lshl_b32 s62, s61, 1
    s_add_u32 s62, s62, s60
    s_add_u32 s62, s62, 1023
    s_cmp_eq_u32 s60, 0
    s_cselect_b32 s61, s61, s62
    s_cselect_b32 s62, 1, 2
    s_cselect_b32 s44, 0x3e8b97f6, 1.0
    s_add_u32 s62, s62, s61
    s_lshl_b32 s24, s61, 11
    s_lshl_b32 s25, s62, 11
    s_mul_i32 s60, s68, 3
    s_add_u32 s60, s60, 1
    s_and_b32 s61, s60, 15
    s_lshl_b32 s61, s61, 6
    s_add_u32 s61, s61, s64
    s_lshr_b32 s60, s60, 4
    s_lshl_b32 s62, s61, 1
    s_add_u32 s62, s62, s60
    s_add_u32 s62, s62, 1023
    s_cmp_eq_u32 s60, 0
    s_cselect_b32 s61, s61, s62
    s_cselect_b32 s62, 1, 2
    s_cselect_b32 s46, 0x3e8b97f6, 1.0
    s_add_u32 s62, s62, s61
    s_lshl_b32 s26, s61, 11
    s_lshl_b32 s27, s62, 11
    s_mul_i32 s60, s68, 3
    s_add_u32 s60, s60, 2
    s_and_b32 s61, s60, 15
    s_lshl_b32 s61, s61, 6
    s_add_u32 s61, s61, s64
    s_lshr_b32 s60, s60, 4
    s_lshl_b32 s62, s61, 1
    s_add_u32 s62, s62, s60
    s_add_u32 s62, s62, 1023
    s_cmp_eq_u32 s60, 0
    s_cselect_b32 s61, s61, s62
    s_cselect_b32 s62, 1, 2
    s_cselect_b32 s96, 0x3e8b97f6, 1.0
    s_add_u32 s62, s62, s61
    s_lshl_b32 s28, s61, 11
    s_lshl_b32 s29, s62, 11
    s_mul_i32 s60, s57, 3
    v_add_u32 v4, s60, v1
    v_and_b32 v5, 7, v4
    v_lshrrev_b32 v4, 3, v4
    v_mul_u32_u24 v5, 12288, v5
    v_lshl_add_u32 v200, v4, 11, v5
    s_lshl_b32 s69, s56, 7
    s_add_u32 s69, s69, 14680064
    v_lshrrev_b32 v4, 4, v1
    v_add_u32 v4, s60, v4
    v_and_b32 v4, 7, v4
    v_and_b32 v5, 15, v1
    v_lshl_add_u32 v4, v4, 4, v5
    v_lshlrev_b32 v201, 8, v4
    s_sub_u32 s61, s56, 4
    s_and_b32 s61, s61, 6
    s_cselect_b32 s61, 0, 0xffff
    s_lshl_b32 s62, 1, s56
    s_cmp_lt_u32 s60, 8
    s_cselect_b32 s98, s62, s61
    s_cmp_lt_u32 s60, 7
    s_cselect_b32 s63, s62, s61
    s_lshl_b32 s63, s63, 16
    s_or_b32 s98, s98, s63
    s_cmp_lt_u32 s60, 6
    s_cselect_b32 s99, s62, s61
    s_cmp_eq_u32 s68, 10
    s_cbranch_scc1 L_p1_TTN
    s_cmp_gt_u32 s68, 10
    s_cbranch_scc1 L_p1_NNN
    s_branch L_p1_TTT
.p2align 12
L_p1_TTT:
    s_waitcnt lgkmcnt(0)
    s_barrier
    ds_read_b64_tr_b16 v[40:41], v18 offset:0
    ds_read_b64_tr_b16 v[42:43], v18 offset:3072
    ds_read_b128 v[24:27], v16 offset:0
    ds_read_b128 v[28:31], v16 offset:2048
    ds_read_b128 v[32:35], v16 offset:4096
    ds_read_b128 v[36:39], v16 offset:6144
    ds_read_b64_tr_b16 v[44:45], v19 offset:0
    ds_read_b64_tr_b16 v[46:47], v19 offset:3072
    ds_read_b64_tr_b16 v[48:49], v20 offset:0
    ds_read_b64_tr_b16 v[50:51], v20 offset:3072
    ds_read_b64_tr_b16 v[52:53], v21 offset:0
    ds_read_b64_tr_b16 v[54:55], v21 offset:3072
    ds_read_b64_tr_b16 v[56:57], v22 offset:0
    ds_read_b64_tr_b16 v[58:59], v22 offset:3072
    ds_read_b64_tr_b16 v[60:61], v23 offset:0
    ds_read_b64_tr_b16 v[62:63], v23 offset:3072
.p2align 3
L_p1l_TTT:
    s_waitcnt lgkmcnt(0)
    s_add_u32 s70, s70, 1
    v_mfma_f32_16x16x32_bf16 v[64:67], v[40:43], v[24:27], v[64:67]
    ds_read_b64_tr_b16 v[176:177], v18 offset:12288
    v_mfma_f32_16x16x32_bf16 v[72:75], v[40:43], v[28:31], v[72:75]
    ds_read_b64_tr_b16 v[178:179], v18 offset:15360
    v_mfma_f32_16x16x32_bf16 v[80:83], v[40:43], v[32:35], v[80:83]
    ds_read_b128 v[160:163], v17 offset:0
    v_mfma_f32_16x16x32_bf16 v[88:91], v[40:43], v[36:39], v[88:91]
    ds_read_b128 v[164:167], v17 offset:2048
    v_mfma_f32_16x16x32_bf16 v[68:71], v[44:47], v[24:27], v[68:71]
    ds_read_b128 v[168:171], v17 offset:4096
    v_mfma_f32_16x16x32_bf16 v[76:79], v[44:47], v[28:31], v[76:79]
    ds_read_b128 v[172:175], v17 offset:6144
    v_mfma_f32_16x16x32_bf16 v[84:87], v[44:47], v[32:35], v[84:87]
    ds_read_b64_tr_b16 v[180:181], v19 offset:12288
    v_mfma_f32_16x16x32_bf16 v[92:95], v[44:47], v[36:39], v[92:95]
    ds_read_b64_tr_b16 v[182:183], v19 offset:15360
    v_mfma_f32_16x16x32_bf16 v[96:99], v[48:51], v[24:27], v[96:99]
    ds_read_b64_tr_b16 v[184:185], v20 offset:12288
    v_mfma_f32_16x16x32_bf16 v[104:107], v[48:51], v[28:31], v[104:107]
    ds_read_b64_tr_b16 v[186:187], v20 offset:15360
    v_mfma_f32_16x16x32_bf16 v[112:115], v[48:51], v[32:35], v[112:115]
    ds_read_b64_tr_b16 v[188:189], v21 offset:12288
    v_mfma_f32_16x16x32_bf16 v[120:123], v[48:51], v[36:39], v[120:123]
    ds_read_b64_tr_b16 v[190:191], v21 offset:15360
    v_mfma_f32_16x16x32_bf16 v[100:103], v[52:55], v[24:27], v[100:103]
    ds_read_b64_tr_b16 v[192:193], v22 offset:12288
    v_mfma_f32_16x16x32_bf16 v[108:111], v[52:55], v[28:31], v[108:111]
    ds_read_b64_tr_b16 v[194:195], v22 offset:15360
    v_mfma_f32_16x16x32_bf16 v[116:119], v[52:55], v[32:35], v[116:119]
    ds_read_b64_tr_b16 v[196:197], v23 offset:12288
    v_mfma_f32_16x16x32_bf16 v[124:127], v[52:55], v[36:39], v[124:127]
    ds_read_b64_tr_b16 v[198:199], v23 offset:15360
    v_mfma_f32_16x16x32_bf16 v[128:131], v[56:59], v[24:27], v[128:131]
    v_add_u32 v16, s65, v16
    v_add_u32 v17, s65, v17
    v_mfma_f32_16x16x32_bf16 v[136:139], v[56:59], v[28:31], v[136:139]
    v_add_u32 v18, s65, v18
    v_add_u32 v19, s65, v19
    v_mfma_f32_16x16x32_bf16 v[144:147], v[56:59], v[32:35], v[144:147]
    v_add_u32 v20, s65, v20
    v_add_u32 v21, s65, v21
    v_mfma_f32_16x16x32_bf16 v[152:155], v[56:59], v[36:39], v[152:155]
    v_add_u32 v22, s65, v22
    v_add_u32 v23, s65, v23
    v_mfma_f32_16x16x32_bf16 v[132:135], v[60:63], v[24:27], v[132:135]
    v_mfma_f32_16x16x32_bf16 v[140:143], v[60:63], v[28:31], v[140:143]
    v_mfma_f32_16x16x32_bf16 v[148:151], v[60:63], v[32:35], v[148:151]
    v_mfma_f32_16x16x32_bf16 v[156:159], v[60:63], v[36:39], v[156:159]
    s_waitcnt lgkmcnt(0)
    s_nop 0
    v_mfma_f32_16x16x32_bf16 v[64:67], v[176:179], v[160:163], v[64:67]
    s_add_u32 s71, s71, 1
    s_cmp_eq_u32 s71, 2
    v_mfma_f32_16x16x32_bf16 v[72:75], v[176:179], v[164:167], v[72:75]
    s_cselect_b32 s71, -1, s71
    s_cselect_b32 s65, s67, s66
    v_mfma_f32_16x16x32_bf16 v[80:83], v[176:179], v[168:171], v[80:83]
    v_mfma_f32_16x16x32_bf16 v[88:91], v[176:179], v[172:175], v[88:91]
    v_mfma_f32_16x16x32_bf16 v[68:71], v[180:183], v[160:163], v[68:71]
    v_mfma_f32_16x16x32_bf16 v[76:79], v[180:183], v[164:167], v[76:79]
    v_mfma_f32_16x16x32_bf16 v[84:87], v[180:183], v[168:171], v[84:87]
    v_mfma_f32_16x16x32_bf16 v[92:95], v[180:183], v[172:175], v[92:95]
    v_mfma_f32_16x16x32_bf16 v[96:99], v[184:187], v[160:163], v[96:99]
    v_mfma_f32_16x16x32_bf16 v[104:107], v[184:187], v[164:167], v[104:107]
    v_mfma_f32_16x16x32_bf16 v[112:115], v[184:187], v[168:171], v[112:115]
    v_mfma_f32_16x16x32_bf16 v[120:123], v[184:187], v[172:175], v[120:123]
    s_barrier
    s_nop 0
    ds_read_b64_tr_b16 v[40:41], v18 offset:0
    ds_read_b64_tr_b16 v[42:43], v18 offset:3072
    v_mfma_f32_16x16x32_bf16 v[100:103], v[188:191], v[160:163], v[100:103]
    ds_read_b128 v[24:27], v16 offset:0
    ds_read_b128 v[28:31], v16 offset:2048
    v_mfma_f32_16x16x32_bf16 v[108:111], v[188:191], v[164:167], v[108:111]
    ds_read_b128 v[32:35], v16 offset:4096
    ds_read_b128 v[36:39], v16 offset:6144
    v_mfma_f32_16x16x32_bf16 v[116:119], v[188:191], v[168:171], v[116:119]
    ds_read_b64_tr_b16 v[44:45], v19 offset:0
    ds_read_b64_tr_b16 v[46:47], v19 offset:3072
    v_mfma_f32_16x16x32_bf16 v[124:127], v[188:191], v[172:175], v[124:127]
    ds_read_b64_tr_b16 v[48:49], v20 offset:0
    ds_read_b64_tr_b16 v[50:51], v20 offset:3072
    v_mfma_f32_16x16x32_bf16 v[128:131], v[192:195], v[160:163], v[128:131]
    ds_read_b64_tr_b16 v[52:53], v21 offset:0
    ds_read_b64_tr_b16 v[54:55], v21 offset:3072
    v_mfma_f32_16x16x32_bf16 v[136:139], v[192:195], v[164:167], v[136:139]
    ds_read_b64_tr_b16 v[56:57], v22 offset:0
    ds_read_b64_tr_b16 v[58:59], v22 offset:3072
    v_mfma_f32_16x16x32_bf16 v[144:147], v[192:195], v[168:171], v[144:147]
    ds_read_b64_tr_b16 v[60:61], v23 offset:0
    ds_read_b64_tr_b16 v[62:63], v23 offset:3072
    v_mfma_f32_16x16x32_bf16 v[152:155], v[192:195], v[172:175], v[152:155]
    v_mfma_f32_16x16x32_bf16 v[132:135], v[196:199], v[160:163], v[132:135]
    v_mfma_f32_16x16x32_bf16 v[140:143], v[196:199], v[164:167], v[140:143]
    v_mfma_f32_16x16x32_bf16 v[148:151], v[196:199], v[168:171], v[148:151]
    v_mfma_f32_16x16x32_bf16 v[156:159], v[196:199], v[172:175], v[156:159]
    s_cmp_lt_u32 s70, 6
    s_cbranch_scc1 L_p1l_TTT
    s_waitcnt lgkmcnt(0)
    s_nop 0
    v_mfma_f32_16x16x32_bf16 v[64:67], v[40:43], v[24:27], v[64:67]
    ds_read_b64_tr_b16 v[176:177], v18 offset:12288
    ds_read_b64_tr_b16 v[178:179], v18 offset:15360
    v_mfma_f32_16x16x32_bf16 v[72:75], v[40:43], v[28:31], v[72:75]
    ds_read_b128 v[160:163], v17 offset:0
    ds_read_b128 v[164:167], v17 offset:2048
    v_mfma_f32_16x16x32_bf16 v[80:83], v[40:43], v[32:35], v[80:83]
    ds_read_b128 v[168:171], v17 offset:4096
    ds_read_b128 v[172:175], v17 offset:6144
    v_mfma_f32_16x16x32_bf16 v[88:91], v[40:43], v[36:39], v[88:91]
    ds_read_b64_tr_b16 v[180:181], v19 offset:12288
    ds_read_b64_tr_b16 v[182:183], v19 offset:15360
    v_mfma_f32_16x16x32_bf16 v[68:71], v[44:47], v[24:27], v[68:71]
    ds_read_b64_tr_b16 v[184:185], v20 offset:12288
    ds_read_b64_tr_b16 v[186:187], v20 offset:15360
    v_mfma_f32_16x16x32_bf16 v[76:79], v[44:47], v[28:31], v[76:79]
    ds_read_b64_tr_b16 v[188:189], v21 offset:12288
    ds_read_b64_tr_b16 v[190:191], v21 offset:15360
    v_mfma_f32_16x16x32_bf16 v[84:87], v[44:47], v[32:35], v[84:87]
    ds_read_b64_tr_b16 v[192:193], v22 offset:12288
    ds_read_b64_tr_b16 v[194:195], v22 offset:15360
    v_mfma_f32_16x16x32_bf16 v[92:95], v[44:47], v[36:39], v[92:95]
    ds_read_b64_tr_b16 v[196:197], v23 offset:12288
    ds_read_b64_tr_b16 v[198:199], v23 offset:15360
    v_mfma_f32_16x16x32_bf16 v[96:99], v[48:51], v[24:27], v[96:99]
    v_mfma_f32_16x16x32_bf16 v[104:107], v[48:51], v[28:31], v[104:107]
    v_mfma_f32_16x16x32_bf16 v[112:115], v[48:51], v[32:35], v[112:115]
    v_mfma_f32_16x16x32_bf16 v[120:123], v[48:51], v[36:39], v[120:123]
    v_mfma_f32_16x16x32_bf16 v[100:103], v[52:55], v[24:27], v[100:103]
    v_mfma_f32_16x16x32_bf16 v[108:111], v[52:55], v[28:31], v[108:111]
    v_mfma_f32_16x16x32_bf16 v[116:119], v[52:55], v[32:35], v[116:119]
    v_mfma_f32_16x16x32_bf16 v[124:127], v[52:55], v[36:39], v[124:127]
    s_waitcnt vmcnt(0) lgkmcnt(0)
    s_barrier
    v_mfma_f32_16x16x32_bf16 v[64:67], v[176:179], v[160:163], v[64:67]
    v_mfma_f32_16x16x32_bf16 v[72:75], v[176:179], v[164:167], v[72:75]
    v_mfma_f32_16x16x32_bf16 v[80:83], v[176:179], v[168:171], v[80:83]
    v_mfma_f32_16x16x32_bf16 v[88:91], v[176:179], v[172:175], v[88:91]
    v_mfma_f32_16x16x32_bf16 v[68:71], v[180:183], v[160:163], v[68:71]
    v_mfma_f32_16x16x32_bf16 v[76:79], v[180:183], v[164:167], v[76:79]
    v_mfma_f32_16x16x32_bf16 v[84:87], v[180:183], v[168:171], v[84:87]
    v_mfma_f32_16x16x32_bf16 v[92:95], v[180:183], v[172:175], v[92:95]
    v_mfma_f32_16x16x32_bf16 v[96:99], v[184:187], v[160:163], v[96:99]
    v_mfma_f32_16x16x32_bf16 v[104:107], v[184:187], v[164:167], v[104:107]
    v_mfma_f32_16x16x32_bf16 v[112:115], v[184:187], v[168:171], v[112:115]
    v_mfma_f32_16x16x32_bf16 v[120:123], v[184:187], v[172:175], v[120:123]
    v_mul_f32 v64, s44, v64
    v_mul_f32 v65, s44, v65
    v_mul_f32 v66, s44, v66
    v_mul_f32 v67, s44, v67
    v_mul_f32 v68, s44, v68
    v_mul_f32 v69, s44, v69
    v_mfma_f32_16x16x32_bf16 v[100:103], v[188:191], v[160:163], v[100:103]
    v_mul_f32 v70, s44, v70
    v_mul_f32 v71, s44, v71
    v_cvt_pk_bf16_f32 v64, v64, v65
    v_cvt_pk_bf16_f32 v65, v66, v67
    v_mfma_f32_16x16x32_bf16 v[108:111], v[188:191], v[164:167], v[108:111]
    v_cvt_pk_bf16_f32 v66, v68, v69
    v_cvt_pk_bf16_f32 v67, v70, v71
    v_mul_f32 v72, s44, v72
    v_mul_f32 v73, s44, v73
    v_mfma_f32_16x16x32_bf16 v[116:119], v[188:191], v[168:171], v[116:119]
    v_mul_f32 v74, s44, v74
    v_mul_f32 v75, s44, v75
    v_mul_f32 v76, s44, v76
    v_mul_f32 v77, s44, v77
    v_mul_f32 v78, s44, v78
    v_mul_f32 v79, s44, v79
    v_mfma_f32_16x16x32_bf16 v[124:127], v[188:191], v[172:175], v[124:127]
    v_cvt_pk_bf16_f32 v68, v72, v73
    v_cvt_pk_bf16_f32 v69, v74, v75
    v_cvt_pk_bf16_f32 v70, v76, v77
    v_mfma_f32_16x16x32_bf16 v[128:131], v[56:59], v[24:27], v[128:131]
    v_cvt_pk_bf16_f32 v71, v78, v79
    buffer_store_dwordx4 v[64:67], v206, s[32:35], s24 offen offset:0 sc1
    v_mul_f32 v80, s44, v80
    v_mul_f32 v81, s44, v81
    v_mfma_f32_16x16x32_bf16 v[136:139], v[56:59], v[28:31], v[136:139]
    v_mul_f32 v82, s44, v82
    v_mul_f32 v83, s44, v83
    v_mul_f32 v84, s44, v84
    v_mul_f32 v85, s44, v85
    v_mul_f32 v86, s44, v86
    v_mul_f32 v87, s44, v87
    v_mfma_f32_16x16x32_bf16 v[144:147], v[56:59], v[32:35], v[144:147]
    v_cvt_pk_bf16_f32 v72, v80, v81
    v_cvt_pk_bf16_f32 v73, v82, v83
    v_cvt_pk_bf16_f32 v74, v84, v85
    v_mfma_f32_16x16x32_bf16 v[152:155], v[56:59], v[36:39], v[152:155]
    v_cvt_pk_bf16_f32 v75, v86, v87
    buffer_store_dwordx4 v[68:71], v206, s[32:35], s24 offen offset:256 sc1
    v_mul_f32 v88, s44, v88
    v_mul_f32 v89, s44, v89
    v_mfma_f32_16x16x32_bf16 v[132:135], v[60:63], v[24:27], v[132:135]
    v_mul_f32 v90, s44, v90
    v_mul_f32 v91, s44, v91
    v_mul_f32 v92, s44, v92
    v_mul_f32 v93, s44, v93
    v_mul_f32 v94, s44, v94
    v_mul_f32 v95, s44, v95
    v_cvt_pk_bf16_f32 v76, v88, v89
    v_mfma_f32_16x16x32_bf16 v[140:143], v[60:63], v[28:31], v[140:143]
    v_cvt_pk_bf16_f32 v77, v90, v91
    v_cvt_pk_bf16_f32 v78, v92, v93
    v_cvt_pk_bf16_f32 v79, v94, v95
    buffer_store_dwordx4 v[72:75], v206, s[32:35], s25 offen offset:0 sc1
    v_mfma_f32_16x16x32_bf16 v[148:151], v[60:63], v[32:35], v[148:151]
    buffer_store_dwordx4 v[76:79], v206, s[32:35], s25 offen offset:256 sc1
    v_mul_f32 v96, s46, v96
    v_mul_f32 v97, s46, v97
    v_mul_f32 v98, s46, v98
    v_mul_f32 v99, s46, v99
    v_mul_f32 v100, s46, v100
    v_mul_f32 v101, s46, v101
    v_mfma_f32_16x16x32_bf16 v[156:159], v[60:63], v[36:39], v[156:159]
    v_mul_f32 v102, s46, v102
    v_mul_f32 v103, s46, v103
    v_cvt_pk_bf16_f32 v96, v96, v97
    v_cvt_pk_bf16_f32 v97, v98, v99
    v_cvt_pk_bf16_f32 v98, v100, v101
    v_mfma_f32_16x16x32_bf16 v[128:131], v[192:195], v[160:163], v[128:131]
    v_cvt_pk_bf16_f32 v99, v102, v103
    v_mul_f32 v104, s46, v104
    v_mul_f32 v105, s46, v105
    v_mul_f32 v106, s46, v106
    v_mul_f32 v107, s46, v107
    v_mul_f32 v108, s46, v108
    v_mul_f32 v109, s46, v109
    v_mfma_f32_16x16x32_bf16 v[136:139], v[192:195], v[164:167], v[136:139]
    v_mul_f32 v110, s46, v110
    v_mul_f32 v111, s46, v111
    v_cvt_pk_bf16_f32 v100, v104, v105
    v_cvt_pk_bf16_f32 v101, v106, v107
    v_cvt_pk_bf16_f32 v102, v108, v109
    v_mfma_f32_16x16x32_bf16 v[144:147], v[192:195], v[168:171], v[144:147]
    v_cvt_pk_bf16_f32 v103, v110, v111
    buffer_store_dwordx4 v[96:99], v206, s[32:35], s26 offen offset:0 sc1
    v_mul_f32 v112, s46, v112
    v_mul_f32 v113, s46, v113
    v_mul_f32 v114, s46, v114
    v_mul_f32 v115, s46, v115
    v_mfma_f32_16x16x32_bf16 v[152:155], v[192:195], v[172:175], v[152:155]
    v_mul_f32 v116, s46, v116
    v_mul_f32 v117, s46, v117
    v_mul_f32 v118, s46, v118
    v_mul_f32 v119, s46, v119
    v_cvt_pk_bf16_f32 v104, v112, v113
    v_cvt_pk_bf16_f32 v105, v114, v115
    v_mfma_f32_16x16x32_bf16 v[132:135], v[196:199], v[160:163], v[132:135]
    v_cvt_pk_bf16_f32 v106, v116, v117
    v_cvt_pk_bf16_f32 v107, v118, v119
    buffer_store_dwordx4 v[100:103], v206, s[32:35], s26 offen offset:256 sc1
    v_mul_f32 v120, s46, v120
    v_mul_f32 v121, s46, v121
    v_mfma_f32_16x16x32_bf16 v[140:143], v[196:199], v[164:167], v[140:143]
    v_mul_f32 v122, s46, v122
    v_mul_f32 v123, s46, v123
    v_mul_f32 v124, s46, v124
    v_mul_f32 v125, s46, v125
    v_mul_f32 v126, s46, v126
    v_mul_f32 v127, s46, v127
    v_cvt_pk_bf16_f32 v108, v120, v121
    v_mfma_f32_16x16x32_bf16 v[148:151], v[196:199], v[168:171], v[148:151]
    v_cvt_pk_bf16_f32 v109, v122, v123
    v_cvt_pk_bf16_f32 v110, v124, v125
    v_cvt_pk_bf16_f32 v111, v126, v127
    buffer_store_dwordx4 v[104:107], v206, s[32:35], s27 offen offset:0 sc1
    v_mfma_f32_16x16x32_bf16 v[156:159], v[196:199], v[172:175], v[156:159]
    buffer_store_dwordx4 v[108:111], v206, s[32:35], s27 offen offset:256 sc1
    v_pk_mul_f32 v[128:129], v[128:129], s[96:97] op_sel_hi:[1,0]
    v_pk_mul_f32 v[130:131], v[130:131], s[96:97] op_sel_hi:[1,0]
    v_pk_mul_f32 v[132:133], v[132:133], s[96:97] op_sel_hi:[1,0]
    v_pk_mul_f32 v[134:135], v[134:135], s[96:97] op_sel_hi:[1,0]
    v_cvt_pk_bf16_f32 v128, v128, v129
    v_cvt_pk_bf16_f32 v129, v130, v131
    v_cvt_pk_bf16_f32 v130, v132, v133
    v_cvt_pk_bf16_f32 v131, v134, v135
    v_pk_mul_f32 v[136:137], v[136:137], s[96:97] op_sel_hi:[1,0]
    v_pk_mul_f32 v[138:139], v[138:139], s[96:97] op_sel_hi:[1,0]
    v_pk_mul_f32 v[140:141], v[140:141], s[96:97] op_sel_hi:[1,0]
    v_pk_mul_f32 v[142:143], v[142:143], s[96:97] op_sel_hi:[1,0]
    v_cvt_pk_bf16_f32 v132, v136, v137
    v_cvt_pk_bf16_f32 v133, v138, v139
    v_cvt_pk_bf16_f32 v134, v140, v141
    v_cvt_pk_bf16_f32 v135, v142, v143
    buffer_store_dwordx4 v[128:131], v206, s[32:35], s28 offen offset:0 sc1
    v_pk_mul_f32 v[144:145], v[144:145], s[96:97] op_sel_hi:[1,0]
    v_pk_mul_f32 v[146:147], v[146:147], s[96:97] op_sel_hi:[1,0]
    v_pk_mul_f32 v[148:149], v[148:149], s[96:97] op_sel_hi:[1,0]
    v_pk_mul_f32 v[150:151], v[150:151], s[96:97] op_sel_hi:[1,0]
    v_cvt_pk_bf16_f32 v136, v144, v145
    v_cvt_pk_bf16_f32 v137, v146, v147
    v_cvt_pk_bf16_f32 v138, v148, v149
    v_cvt_pk_bf16_f32 v139, v150, v151
    buffer_store_dwordx4 v[132:135], v206, s[32:35], s28 offen offset:256 sc1
    v_pk_mul_f32 v[152:153], v[152:153], s[96:97] op_sel_hi:[1,0]
    v_pk_mul_f32 v[154:155], v[154:155], s[96:97] op_sel_hi:[1,0]
    v_pk_mul_f32 v[156:157], v[156:157], s[96:97] op_sel_hi:[1,0]
    v_pk_mul_f32 v[158:159], v[158:159], s[96:97] op_sel_hi:[1,0]
    v_cvt_pk_bf16_f32 v140, v152, v153
    v_cvt_pk_bf16_f32 v141, v154, v155
    v_cvt_pk_bf16_f32 v142, v156, v157
    v_cvt_pk_bf16_f32 v143, v158, v159
    buffer_store_dwordx4 v[136:139], v206, s[32:35], s29 offen offset:0 sc1
    buffer_store_dwordx4 v[140:143], v206, s[32:35], s29 offen offset:256 sc1
    s_branch L_dA
.p2align 12
L_p1_TTN:
    s_waitcnt lgkmcnt(0)
    s_barrier
    ds_read_b64_tr_b16 v[40:41], v18 offset:0
    ds_read_b64_tr_b16 v[42:43], v18 offset:3072
    ds_read_b128 v[24:27], v16 offset:0
    ds_read_b128 v[28:31], v16 offset:2048
    ds_read_b128 v[32:35], v16 offset:4096
    ds_read_b128 v[36:39], v16 offset:6144
    ds_read_b64_tr_b16 v[44:45], v19 offset:0
    ds_read_b64_tr_b16 v[46:47], v19 offset:3072
    ds_read_b64_tr_b16 v[48:49], v20 offset:0
    ds_read_b64_tr_b16 v[50:51], v20 offset:3072
    ds_read_b64_tr_b16 v[52:53], v21 offset:0
    ds_read_b64_tr_b16 v[54:55], v21 offset:3072
    ds_read_b64_tr_b16 v[56:57], v22 offset:0
    ds_read_b64_tr_b16 v[58:59], v22 offset:3072
    ds_read_b64_tr_b16 v[60:61], v23 offset:0
    ds_read_b64_tr_b16 v[62:63], v23 offset:3072
.p2align 3
L_p1l_TTN:
    s_waitcnt lgkmcnt(0)
    s_add_u32 s70, s70, 1
    v_mfma_f32_16x16x32_bf16 v[64:67], v[40:43], v[24:27], v[64:67]
    ds_read_b64_tr_b16 v[176:177], v18 offset:12288
    v_mfma_f32_16x16x32_bf16 v[72:75], v[40:43], v[28:31], v[72:75]
    ds_read_b64_tr_b16 v[178:179], v18 offset:15360
    v_mfma_f32_16x16x32_bf16 v[80:83], v[40:43], v[32:35], v[80:83]
    ds_read_b128 v[160:163], v17 offset:0
    v_mfma_f32_16x16x32_bf16 v[88:91], v[40:43], v[36:39], v[88:91]
    ds_read_b128 v[164:167], v17 offset:2048
    v_mfma_f32_16x16x32_bf16 v[68:71], v[44:47], v[24:27], v[68:71]
    ds_read_b128 v[168:171], v17 offset:4096
    v_mfma_f32_16x16x32_bf16 v[76:79], v[44:47], v[28:31], v[76:79]
    ds_read_b128 v[172:175], v17 offset:6144
    v_mfma_f32_16x16x32_bf16 v[84:87], v[44:47], v[32:35], v[84:87]
    ds_read_b64_tr_b16 v[180:181], v19 offset:12288
    v_mfma_f32_16x16x32_bf16 v[92:95], v[44:47], v[36:39], v[92:95]
    ds_read_b64_tr_b16 v[182:183], v19 offset:15360
    v_mfma_f32_16x16x32_bf16 v[96:99], v[48:51], v[24:27], v[96:99]
    ds_read_b64_tr_b16 v[184:185], v20 offset:12288
    v_mfma_f32_16x16x32_bf16 v[104:107], v[48:51], v[28:31], v[104:107]
    ds_read_b64_tr_b16 v[186:187], v20 offset:15360
    v_mfma_f32_16x16x32_bf16 v[112:115], v[48:51], v[32:35], v[112:115]
    ds_read_b64_tr_b16 v[188:189], v21 offset:12288
    v_mfma_f32_16x16x32_bf16 v[120:123], v[48:51], v[36:39], v[120:123]
    ds_read_b64_tr_b16 v[190:191], v21 offset:15360
    v_mfma_f32_16x16x32_bf16 v[100:103], v[52:55], v[24:27], v[100:103]
    ds_read_b64_tr_b16 v[192:193], v22 offset:12288
    v_mfma_f32_16x16x32_bf16 v[108:111], v[52:55], v[28:31], v[108:111]
    ds_read_b64_tr_b16 v[194:195], v22 offset:15360
    v_mfma_f32_16x16x32_bf16 v[116:119], v[52:55], v[32:35], v[116:119]
    ds_read_b64_tr_b16 v[196:197], v23 offset:12288
    v_mfma_f32_16x16x32_bf16 v[124:127], v[52:55], v[36:39], v[124:127]
    ds_read_b64_tr_b16 v[198:199], v23 offset:15360
    v_mfma_f32_16x16x32_bf16 v[128:131], v[24:27], v[56:59], v[128:131]
    v_add_u32 v16, s65, v16
    v_add_u32 v17, s65, v17
    v_mfma_f32_16x16x32_bf16 v[132:135], v[28:31], v[56:59], v[132:135]
    v_add_u32 v18, s65, v18
    v_add_u32 v19, s65, v19
    v_mfma_f32_16x16x32_bf16 v[144:147], v[32:35], v[56:59], v[144:147]
    v_add_u32 v20, s65, v20
    v_add_u32 v21, s65, v21
    v_mfma_f32_16x16x32_bf16 v[148:151], v[36:39], v[56:59], v[148:151]
    v_add_u32 v22, s65, v22
    v_add_u32 v23, s65, v23
    v_mfma_f32_16x16x32_bf16 v[136:139], v[24:27], v[60:63], v[136:139]
    v_mfma_f32_16x16x32_bf16 v[140:143], v[28:31], v[60:63], v[140:143]
    v_mfma_f32_16x16x32_bf16 v[152:155], v[32:35], v[60:63], v[152:155]
    v_mfma_f32_16x16x32_bf16 v[156:159], v[36:39], v[60:63], v[156:159]
    s_waitcnt lgkmcnt(0)
    s_nop 0
    v_mfma_f32_16x16x32_bf16 v[64:67], v[176:179], v[160:163], v[64:67]
    s_add_u32 s71, s71, 1
    s_cmp_eq_u32 s71, 2
    v_mfma_f32_16x16x32_bf16 v[72:75], v[176:179], v[164:167], v[72:75]
    s_cselect_b32 s71, -1, s71
    s_cselect_b32 s65, s67, s66
    v_mfma_f32_16x16x32_bf16 v[80:83], v[176:179], v[168:171], v[80:83]
    v_mfma_f32_16x16x32_bf16 v[88:91], v[176:179], v[172:175], v[88:91]
    v_mfma_f32_16x16x32_bf16 v[68:71], v[180:183], v[160:163], v[68:71]
    v_mfma_f32_16x16x32_bf16 v[76:79], v[180:183], v[164:167], v[76:79]
    v_mfma_f32_16x16x32_bf16 v[84:87], v[180:183], v[168:171], v[84:87]
    v_mfma_f32_16x16x32_bf16 v[92:95], v[180:183], v[172:175], v[92:95]
    v_mfma_f32_16x16x32_bf16 v[96:99], v[184:187], v[160:163], v[96:99]
    v_mfma_f32_16x16x32_bf16 v[104:107], v[184:187], v[164:167], v[104:107]
    v_mfma_f32_16x16x32_bf16 v[112:115], v[184:187], v[168:171], v[112:115]
    v_mfma_f32_16x16x32_bf16 v[120:123], v[184:187], v[172:175], v[120:123]
    s_barrier
    s_nop 0
    ds_read_b64_tr_b16 v[40:41], v18 offset:0
    ds_read_b64_tr_b16 v[42:43], v18 offset:3072
    v_mfma_f32_16x16x32_bf16 v[100:103], v[188:191], v[160:163], v[100:103]
    ds_read_b128 v[24:27], v16 offset:0
    ds_read_b128 v[28:31], v16 offset:2048
    v_mfma_f32_16x16x32_bf16 v[108:111], v[188:191], v[164:167], v[108:111]
    ds_read_b128 v[32:35], v16 offset:4096
    ds_read_b128 v[36:39], v16 offset:6144
    v_mfma_f32_16x16x32_bf16 v[116:119], v[188:191], v[168:171], v[116:119]
    ds_read_b64_tr_b16 v[44:45], v19 offset:0
    ds_read_b64_tr_b16 v[46:47], v19 offset:3072
    v_mfma_f32_16x16x32_bf16 v[124:127], v[188:191], v[172:175], v[124:127]
    ds_read_b64_tr_b16 v[48:49], v20 offset:0
    ds_read_b64_tr_b16 v[50:51], v20 offset:3072
    v_mfma_f32_16x16x32_bf16 v[128:131], v[160:163], v[192:195], v[128:131]
    ds_read_b64_tr_b16 v[52:53], v21 offset:0
    ds_read_b64_tr_b16 v[54:55], v21 offset:3072
    v_mfma_f32_16x16x32_bf16 v[132:135], v[164:167], v[192:195], v[132:135]
    ds_read_b64_tr_b16 v[56:57], v22 offset:0
    ds_read_b64_tr_b16 v[58:59], v22 offset:3072
    v_mfma_f32_16x16x32_bf16 v[144:147], v[168:171], v[192:195], v[144:147]
    ds_read_b64_tr_b16 v[60:61], v23 offset:0
    ds_read_b64_tr_b16 v[62:63], v23 offset:3072
    v_mfma_f32_16x16x32_bf16 v[148:151], v[172:175], v[192:195], v[148:151]
    v_mfma_f32_16x16x32_bf16 v[136:139], v[160:163], v[196:199], v[136:139]
    v_mfma_f32_16x16x32_bf16 v[140:143], v[164:167], v[196:199], v[140:143]
    v_mfma_f32_16x16x32_bf16 v[152:155], v[168:171], v[196:199], v[152:155]
    v_mfma_f32_16x16x32_bf16 v[156:159], v[172:175], v[196:199], v[156:159]
    s_cmp_lt_u32 s70, 6
    s_cbranch_scc1 L_p1l_TTN
    s_waitcnt lgkmcnt(0)
    s_nop 0
    v_mfma_f32_16x16x32_bf16 v[64:67], v[40:43], v[24:27], v[64:67]
    ds_read_b64_tr_b16 v[176:177], v18 offset:12288
    ds_read_b64_tr_b16 v[178:179], v18 offset:15360
    v_mfma_f32_16x16x32_bf16 v[72:75], v[40:43], v[28:31], v[72:75]
    ds_read_b128 v[160:163], v17 offset:0
    ds_read_b128 v[164:167], v17 offset:2048
    v_mfma_f32_16x16x32_bf16 v[80:83], v[40:43], v[32:35], v[80:83]
    ds_read_b128 v[168:171], v17 offset:4096
    ds_read_b128 v[172:175], v17 offset:6144
    v_mfma_f32_16x16x32_bf16 v[88:91], v[40:43], v[36:39], v[88:91]
    ds_read_b64_tr_b16 v[180:181], v19 offset:12288
    ds_read_b64_tr_b16 v[182:183], v19 offset:15360
    v_mfma_f32_16x16x32_bf16 v[68:71], v[44:47], v[24:27], v[68:71]
    ds_read_b64_tr_b16 v[184:185], v20 offset:12288
    ds_read_b64_tr_b16 v[186:187], v20 offset:15360
    v_mfma_f32_16x16x32_bf16 v[76:79], v[44:47], v[28:31], v[76:79]
    ds_read_b64_tr_b16 v[188:189], v21 offset:12288
    ds_read_b64_tr_b16 v[190:191], v21 offset:15360
    v_mfma_f32_16x16x32_bf16 v[84:87], v[44:47], v[32:35], v[84:87]
    ds_read_b64_tr_b16 v[192:193], v22 offset:12288
    ds_read_b64_tr_b16 v[194:195], v22 offset:15360
    v_mfma_f32_16x16x32_bf16 v[92:95], v[44:47], v[36:39], v[92:95]
    ds_read_b64_tr_b16 v[196:197], v23 offset:12288
    ds_read_b64_tr_b16 v[198:199], v23 offset:15360
    v_mfma_f32_16x16x32_bf16 v[96:99], v[48:51], v[24:27], v[96:99]
    v_mfma_f32_16x16x32_bf16 v[104:107], v[48:51], v[28:31], v[104:107]
    v_mfma_f32_16x16x32_bf16 v[112:115], v[48:51], v[32:35], v[112:115]
    v_mfma_f32_16x16x32_bf16 v[120:123], v[48:51], v[36:39], v[120:123]
    v_mfma_f32_16x16x32_bf16 v[100:103], v[52:55], v[24:27], v[100:103]
    v_mfma_f32_16x16x32_bf16 v[108:111], v[52:55], v[28:31], v[108:111]
    v_mfma_f32_16x16x32_bf16 v[116:119], v[52:55], v[32:35], v[116:119]
    v_mfma_f32_16x16x32_bf16 v[124:127], v[52:55], v[36:39], v[124:127]
    s_waitcnt vmcnt(0) lgkmcnt(0)
    s_barrier
    v_mfma_f32_16x16x32_bf16 v[64:67], v[176:179], v[160:163], v[64:67]
    v_mfma_f32_16x16x32_bf16 v[72:75], v[176:179], v[164:167], v[72:75]
    v_mfma_f32_16x16x32_bf16 v[80:83], v[176:179], v[168:171], v[80:83]
    v_mfma_f32_16x16x32_bf16 v[88:91], v[176:179], v[172:175], v[88:91]
    v_mfma_f32_16x16x32_bf16 v[68:71], v[180:183], v[160:163], v[68:71]
    v_mfma_f32_16x16x32_bf16 v[76:79], v[180:183], v[164:167], v[76:79]
    v_mfma_f32_16x16x32_bf16 v[84:87], v[180:183], v[168:171], v[84:87]
    v_mfma_f32_16x16x32_bf16 v[92:95], v[180:183], v[172:175], v[92:95]
    v_mfma_f32_16x16x32_bf16 v[96:99], v[184:187], v[160:163], v[96:99]
    v_mfma_f32_16x16x32_bf16 v[104:107], v[184:187], v[164:167], v[104:107]
    v_mfma_f32_16x16x32_bf16 v[112:115], v[184:187], v[168:171], v[112:115]
    v_mfma_f32_16x16x32_bf16 v[120:123], v[184:187], v[172:175], v[120:123]
    v_cvt_pk_bf16_f32 v64, v64, v65
    v_cvt_pk_bf16_f32 v65, v66, v67
    v_mfma_f32_16x16x32_bf16 v[100:103], v[188:191], v[160:163], v[100:103]
    v_cvt_pk_bf16_f32 v66, v68, v69
    v_cvt_pk_bf16_f32 v67, v70, v71
    v_mfma_f32_16x16x32_bf16 v[108:111], v[188:191], v[164:167], v[108:111]
    v_cvt_pk_bf16_f32 v68, v72, v73
    v_cvt_pk_bf16_f32 v69, v74, v75
    v_mfma_f32_16x16x32_bf16 v[116:119], v[188:191], v[168:171], v[116:119]
    v_cvt_pk_bf16_f32 v70, v76, v77
    v_cvt_pk_bf16_f32 v71, v78, v79
    v_mfma_f32_16x16x32_bf16 v[124:127], v[188:191], v[172:175], v[124:127]
    buffer_store_dwordx4 v[64:67], v206, s[32:35], s24 offen offset:0 sc1
    v_cvt_pk_bf16_f32 v72, v80, v81
    v_mfma_f32_16x16x32_bf16 v[128:131], v[24:27], v[56:59], v[128:131]
    v_cvt_pk_bf16_f32 v73, v82, v83
    v_cvt_pk_bf16_f32 v74, v84, v85
    v_mfma_f32_16x16x32_bf16 v[132:135], v[28:31], v[56:59], v[132:135]
    v_cvt_pk_bf16_f32 v75, v86, v87
    buffer_store_dwordx4 v[68:71], v206, s[32:35], s24 offen offset:256 sc1
    v_mfma_f32_16x16x32_bf16 v[144:147], v[32:35], v[56:59], v[144:147]
    v_cvt_pk_bf16_f32 v76, v88, v89
    v_cvt_pk_bf16_f32 v77, v90, v91
    v_mfma_f32_16x16x32_bf16 v[148:151], v[36:39], v[56:59], v[148:151]
    v_cvt_pk_bf16_f32 v78, v92, v93
    v_cvt_pk_bf16_f32 v79, v94, v95
    v_mfma_f32_16x16x32_bf16 v[136:139], v[24:27], v[60:63], v[136:139]
    buffer_store_dwordx4 v[72:75], v206, s[32:35], s25 offen offset:0 sc1
    buffer_store_dwordx4 v[76:79], v206, s[32:35], s25 offen offset:256 sc1
    v_cvt_pk_bf16_f32 v96, v96, v97
    v_mfma_f32_16x16x32_bf16 v[140:143], v[28:31], v[60:63], v[140:143]
    v_cvt_pk_bf16_f32 v97, v98, v99
    v_cvt_pk_bf16_f32 v98, v100, v101
    v_cvt_pk_bf16_f32 v99, v102, v103
    v_mfma_f32_16x16x32_bf16 v[152:155], v[32:35], v[60:63], v[152:155]
    v_cvt_pk_bf16_f32 v100, v104, v105
    v_cvt_pk_bf16_f32 v101, v106, v107
    v_cvt_pk_bf16_f32 v102, v108, v109
    v_mfma_f32_16x16x32_bf16 v[156:159], v[36:39], v[60:63], v[156:159]
    v_cvt_pk_bf16_f32 v103, v110, v111
    buffer_store_dwordx4 v[96:99], v206, s[32:35], s26 offen offset:0 sc1
    v_cvt_pk_bf16_f32 v104, v112, v113
    v_mfma_f32_16x16x32_bf16 v[128:131], v[160:163], v[192:195], v[128:131]
    v_cvt_pk_bf16_f32 v105, v114, v115
    v_cvt_pk_bf16_f32 v106, v116, v117
    v_cvt_pk_bf16_f32 v107, v118, v119
    v_mfma_f32_16x16x32_bf16 v[132:135], v[164:167], v[192:195], v[132:135]
    buffer_store_dwordx4 v[100:103], v206, s[32:35], s26 offen offset:256 sc1
    v_cvt_pk_bf16_f32 v108, v120, v121
    v_cvt_pk_bf16_f32 v109, v122, v123
    v_mfma_f32_16x16x32_bf16 v[144:147], v[168:171], v[192:195], v[144:147]
    v_cvt_pk_bf16_f32 v110, v124, v125
    v_cvt_pk_bf16_f32 v111, v126, v127
    buffer_store_dwordx4 v[104:107], v206, s[32:35], s27 offen offset:0 sc1
    v_mfma_f32_16x16x32_bf16 v[148:151], v[172:175], v[192:195], v[148:151]
    buffer_store_dwordx4 v[108:111], v206, s[32:35], s27 offen offset:256 sc1
    v_mfma_f32_16x16x32_bf16 v[136:139], v[160:163], v[196:199], v[136:139]
    v_mfma_f32_16x16x32_bf16 v[140:143], v[164:167], v[196:199], v[140:143]
    v_mfma_f32_16x16x32_bf16 v[152:155], v[168:171], v[196:199], v[152:155]
    v_mfma_f32_16x16x32_bf16 v[156:159], v[172:175], v[196:199], v[156:159]
    v_cvt_pk_bf16_f32 v128, v128, v129
    v_cvt_pk_bf16_f32 v129, v130, v131
    v_cvt_pk_bf16_f32 v130, v132, v133
    v_cvt_pk_bf16_f32 v131, v134, v135
    s_nop 0
    v_cvt_pk_bf16_f32 v132, v136, v137
    v_cvt_pk_bf16_f32 v133, v138, v139
    v_cvt_pk_bf16_f32 v134, v140, v141
    v_cvt_pk_bf16_f32 v135, v142, v143
    v_permlane16_swap_b32 v128, v130
    v_permlane16_swap_b32 v129, v131
    buffer_store_dwordx4 v[128:131], v206, s[32:35], s28 offen offset:0 sc1
    v_cvt_pk_bf16_f32 v136, v144, v145
    v_cvt_pk_bf16_f32 v137, v146, v147
    v_cvt_pk_bf16_f32 v138, v148, v149
    v_cvt_pk_bf16_f32 v139, v150, v151
    v_permlane16_swap_b32 v132, v134
    v_permlane16_swap_b32 v133, v135
    buffer_store_dwordx4 v[132:135], v206, s[32:35], s28 offen offset:256 sc1
    v_cvt_pk_bf16_f32 v140, v152, v153
    v_cvt_pk_bf16_f32 v141, v154, v155
    v_cvt_pk_bf16_f32 v142, v156, v157
    v_cvt_pk_bf16_f32 v143, v158, v159
    v_permlane16_swap_b32 v136, v138
    v_permlane16_swap_b32 v137, v139
    buffer_store_dwordx4 v[136:139], v206, s[32:35], s29 offen offset:0 sc1
    v_permlane16_swap_b32 v140, v142
    v_permlane16_swap_b32 v141, v143
    buffer_store_dwordx4 v[140:143], v206, s[32:35], s29 offen offset:256 sc1
    s_branch L_dA
.p2align 12
L_p1_NNN:
    s_waitcnt lgkmcnt(0)
    s_barrier
    ds_read_b64_tr_b16 v[40:41], v18 offset:0
    ds_read_b64_tr_b16 v[42:43], v18 offset:3072
    ds_read_b128 v[24:27], v16 offset:0
    ds_read_b128 v[28:31], v16 offset:2048
    ds_read_b128 v[32:35], v16 offset:4096
    ds_read_b128 v[36:39], v16 offset:6144
    ds_read_b64_tr_b16 v[44:45], v19 offset:0
    ds_read_b64_tr_b16 v[46:47], v19 offset:3072
    ds_read_b64_tr_b16 v[48:49], v20 offset:0
    ds_read_b64_tr_b16 v[50:51], v20 offset:3072
    ds_read_b64_tr_b16 v[52:53], v21 offset:0
    ds_read_b64_tr_b16 v[54:55], v21 offset:3072
    ds_read_b64_tr_b16 v[56:57], v22 offset:0
    ds_read_b64_tr_b16 v[58:59], v22 offset:3072
    ds_read_b64_tr_b16 v[60:61], v23 offset:0
    ds_read_b64_tr_b16 v[62:63], v23 offset:3072
.p2align 3
L_p1l_NNN:
    s_waitcnt lgkmcnt(0)
    s_add_u32 s70, s70, 1
    v_mfma_f32_16x16x32_bf16 v[64:67], v[24:27], v[40:43], v[64:67]
    ds_read_b64_tr_b16 v[176:177], v18 offset:12288
    v_mfma_f32_16x16x32_bf16 v[68:71], v[28:31], v[40:43], v[68:71]
    ds_read_b64_tr_b16 v[178:179], v18 offset:15360
    v_mfma_f32_16x16x32_bf16 v[80:83], v[32:35], v[40:43], v[80:83]
    ds_read_b128 v[160:163], v17 offset:0
    v_mfma_f32_16x16x32_bf16 v[84:87], v[36:39], v[40:43], v[84:87]
    ds_read_b128 v[164:167], v17 offset:2048
    v_mfma_f32_16x16x32_bf16 v[72:75], v[24:27], v[44:47], v[72:75]
    ds_read_b128 v[168:171], v17 offset:4096
    v_mfma_f32_16x16x32_bf16 v[76:79], v[28:31], v[44:47], v[76:79]
    ds_read_b128 v[172:175], v17 offset:6144
    v_mfma_f32_16x16x32_bf16 v[88:91], v[32:35], v[44:47], v[88:91]
    ds_read_b64_tr_b16 v[180:181], v19 offset:12288
    v_mfma_f32_16x16x32_bf16 v[92:95], v[36:39], v[44:47], v[92:95]
    ds_read_b64_tr_b16 v[182:183], v19 offset:15360
    v_mfma_f32_16x16x32_bf16 v[96:99], v[24:27], v[48:51], v[96:99]
    ds_read_b64_tr_b16 v[184:185], v20 offset:12288
    v_mfma_f32_16x16x32_bf16 v[100:103], v[28:31], v[48:51], v[100:103]
    ds_read_b64_tr_b16 v[186:187], v20 offset:15360
    v_mfma_f32_16x16x32_bf16 v[112:115], v[32:35], v[48:51], v[112:115]
    ds_read_b64_tr_b16 v[188:189], v21 offset:12288
    v_mfma_f32_16x16x32_bf16 v[116:119], v[36:39], v[48:51], v[116:119]
    ds_read_b64_tr_b16 v[190:191], v21 offset:15360
    v_mfma_f32_16x16x32_bf16 v[104:107], v[24:27], v[52:55], v[104:107]
    ds_read_b64_tr_b16 v[192:193], v22 offset:12288
    v_mfma_f32_16x16x32_bf16 v[108:111], v[28:31], v[52:55], v[108:111]
    ds_read_b64_tr_b16 v[194:195], v22 offset:15360
    v_mfma_f32_16x16x32_bf16 v[120:123], v[32:35], v[52:55], v[120:123]
    ds_read_b64_tr_b16 v[196:197], v23 offset:12288
    v_mfma_f32_16x16x32_bf16 v[124:127], v[36:39], v[52:55], v[124:127]
    ds_read_b64_tr_b16 v[198:199], v23 offset:15360
    v_mfma_f32_16x16x32_bf16 v[128:131], v[24:27], v[56:59], v[128:131]
    v_add_u32 v16, s65, v16
    v_add_u32 v17, s65, v17
    v_mfma_f32_16x16x32_bf16 v[132:135], v[28:31], v[56:59], v[132:135]
    v_add_u32 v18, s65, v18
    v_add_u32 v19, s65, v19
    v_mfma_f32_16x16x32_bf16 v[144:147], v[32:35], v[56:59], v[144:147]
    v_add_u32 v20, s65, v20
    v_add_u32 v21, s65, v21
    v_mfma_f32_16x16x32_bf16 v[148:151], v[36:39], v[56:59], v[148:151]
    v_add_u32 v22, s65, v22
    v_add_u32 v23, s65, v23
    v_mfma_f32_16x16x32_bf16 v[136:139], v[24:27], v[60:63], v[136:139]
    v_mfma_f32_16x16x32_bf16 v[140:143], v[28:31], v[60:63], v[140:143]
    v_mfma_f32_16x16x32_bf16 v[152:155], v[32:35], v[60:63], v[152:155]
    v_mfma_f32_16x16x32_bf16 v[156:159], v[36:39], v[60:63], v[156:159]
    s_waitcnt lgkmcnt(0)
    s_nop 0
    v_mfma_f32_16x16x32_bf16 v[64:67], v[160:163], v[176:179], v[64:67]
    s_add_u32 s71, s71, 1
    s_cmp_eq_u32 s71, 2
    v_mfma_f32_16x16x32_bf16 v[68:71], v[164:167], v[176:179], v[68:71]
    s_cselect_b32 s71, -1, s71
    s_cselect_b32 s65, s67, s66
    v_mfma_f32_16x16x32_bf16 v[80:83], v[168:171], v[176:179], v[80:83]
    v_mfma_f32_16x16x32_bf16 v[84:87], v[172:175], v[176:179], v[84:87]
    v_mfma_f32_16x16x32_bf16 v[72:75], v[160:163], v[180:183], v[72:75]
    v_mfma_f32_16x16x32_bf16 v[76:79], v[164:167], v[180:183], v[76:79]
    v_mfma_f32_16x16x32_bf16 v[88:91], v[168:171], v[180:183], v[88:91]
    v_mfma_f32_16x16x32_bf16 v[92:95], v[172:175], v[180:183], v[92:95]
    v_mfma_f32_16x16x32_bf16 v[96:99], v[160:163], v[184:187], v[96:99]
    v_mfma_f32_16x16x32_bf16 v[100:103], v[164:167], v[184:187], v[100:103]
    v_mfma_f32_16x16x32_bf16 v[112:115], v[168:171], v[184:187], v[112:115]
    v_mfma_f32_16x16x32_bf16 v[116:119], v[172:175], v[184:187], v[116:119]
    s_barrier
    s_nop 0
    ds_read_b64_tr_b16 v[40:41], v18 offset:0
    ds_read_b64_tr_b16 v[42:43], v18 offset:3072
    v_mfma_f32_16x16x32_bf16 v[104:107], v[160:163], v[188:191], v[104:107]
    ds_read_b128 v[24:27], v16 offset:0
    ds_read_b128 v[28:31], v16 offset:2048
    v_mfma_f32_16x16x32_bf16 v[108:111], v[164:167], v[188:191], v[108:111]
    ds_read_b128 v[32:35], v16 offset:4096
    ds_read_b128 v[36:39], v16 offset:6144
    v_mfma_f32_16x16x32_bf16 v[120:123], v[168:171], v[188:191], v[120:123]
    ds_read_b64_tr_b16 v[44:45], v19 offset:0
    ds_read_b64_tr_b16 v[46:47], v19 offset:3072
    v_mfma_f32_16x16x32_bf16 v[124:127], v[172:175], v[188:191], v[124:127]
    ds_read_b64_tr_b16 v[48:49], v20 offset:0
    ds_read_b64_tr_b16 v[50:51], v20 offset:3072
    v_mfma_f32_16x16x32_bf16 v[128:131], v[160:163], v[192:195], v[128:131]
    ds_read_b64_tr_b16 v[52:53], v21 offset:0
    ds_read_b64_tr_b16 v[54:55], v21 offset:3072
    v_mfma_f32_16x16x32_bf16 v[132:135], v[164:167], v[192:195], v[132:135]
    ds_read_b64_tr_b16 v[56:57], v22 offset:0
    ds_read_b64_tr_b16 v[58:59], v22 offset:3072
    v_mfma_f32_16x16x32_bf16 v[144:147], v[168:171], v[192:195], v[144:147]
    ds_read_b64_tr_b16 v[60:61], v23 offset:0
    ds_read_b64_tr_b16 v[62:63], v23 offset:3072
    v_mfma_f32_16x16x32_bf16 v[148:151], v[172:175], v[192:195], v[148:151]
    v_mfma_f32_16x16x32_bf16 v[136:139], v[160:163], v[196:199], v[136:139]
    v_mfma_f32_16x16x32_bf16 v[140:143], v[164:167], v[196:199], v[140:143]
    v_mfma_f32_16x16x32_bf16 v[152:155], v[168:171], v[196:199], v[152:155]
    v_mfma_f32_16x16x32_bf16 v[156:159], v[172:175], v[196:199], v[156:159]
    s_cmp_lt_u32 s70, 6
    s_cbranch_scc1 L_p1l_NNN
    s_waitcnt lgkmcnt(0)
    s_nop 0
    v_mfma_f32_16x16x32_bf16 v[64:67], v[24:27], v[40:43], v[64:67]
    ds_read_b64_tr_b16 v[176:177], v18 offset:12288
    ds_read_b64_tr_b16 v[178:179], v18 offset:15360
    v_mfma_f32_16x16x32_bf16 v[68:71], v[28:31], v[40:43], v[68:71]
    ds_read_b128 v[160:163], v17 offset:0
    ds_read_b128 v[164:167], v17 offset:2048
    v_mfma_f32_16x16x32_bf16 v[80:83], v[32:35], v[40:43], v[80:83]
    ds_read_b128 v[168:171], v17 offset:4096
    ds_read_b128 v[172:175], v17 offset:6144
    v_mfma_f32_16x16x32_bf16 v[84:87], v[36:39], v[40:43], v[84:87]
    ds_read_b64_tr_b16 v[180:181], v19 offset:12288
    ds_read_b64_tr_b16 v[182:183], v19 offset:15360
    v_mfma_f32_16x16x32_bf16 v[72:75], v[24:27], v[44:47], v[72:75]
    ds_read_b64_tr_b16 v[184:185], v20 offset:12288
    ds_read_b64_tr_b16 v[186:187], v20 offset:15360
    v_mfma_f32_16x16x32_bf16 v[76:79], v[28:31], v[44:47], v[76:79]
    ds_read_b64_tr_b16 v[188:189], v21 offset:12288
    ds_read_b64_tr_b16 v[190:191], v21 offset:15360
    v_mfma_f32_16x16x32_bf16 v[88:91], v[32:35], v[44:47], v[88:91]
    ds_read_b64_tr_b16 v[192:193], v22 offset:12288
    ds_read_b64_tr_b16 v[194:195], v22 offset:15360
    v_mfma_f32_16x16x32_bf16 v[92:95], v[36:39], v[44:47], v[92:95]
    ds_read_b64_tr_b16 v[196:197], v23 offset:12288
    ds_read_b64_tr_b16 v[198:199], v23 offset:15360
    v_mfma_f32_16x16x32_bf16 v[96:99], v[24:27], v[48:51], v[96:99]
    v_mfma_f32_16x16x32_bf16 v[100:103], v[28:31], v[48:51], v[100:103]
    v_mfma_f32_16x16x32_bf16 v[112:115], v[32:35], v[48:51], v[112:115]
    v_mfma_f32_16x16x32_bf16 v[116:119], v[36:39], v[48:51], v[116:119]
    v_mfma_f32_16x16x32_bf16 v[104:107], v[24:27], v[52:55], v[104:107]
    v_mfma_f32_16x16x32_bf16 v[108:111], v[28:31], v[52:55], v[108:111]
    v_mfma_f32_16x16x32_bf16 v[120:123], v[32:35], v[52:55], v[120:123]
    v_mfma_f32_16x16x32_bf16 v[124:127], v[36:39], v[52:55], v[124:127]
    s_waitcnt vmcnt(0) lgkmcnt(0)
    s_barrier
    v_mfma_f32_16x16x32_bf16 v[64:67], v[160:163], v[176:179], v[64:67]
    v_mfma_f32_16x16x32_bf16 v[68:71], v[164:167], v[176:179], v[68:71]
    v_mfma_f32_16x16x32_bf16 v[80:83], v[168:171], v[176:179], v[80:83]
    v_mfma_f32_16x16x32_bf16 v[84:87], v[172:175], v[176:179], v[84:87]
    v_mfma_f32_16x16x32_bf16 v[72:75], v[160:163], v[180:183], v[72:75]
    v_mfma_f32_16x16x32_bf16 v[76:79], v[164:167], v[180:183], v[76:79]
    v_mfma_f32_16x16x32_bf16 v[88:91], v[168:171], v[180:183], v[88:91]
    v_mfma_f32_16x16x32_bf16 v[92:95], v[172:175], v[180:183], v[92:95]
    v_mfma_f32_16x16x32_bf16 v[96:99], v[160:163], v[184:187], v[96:99]
    v_mfma_f32_16x16x32_bf16 v[100:103], v[164:167], v[184:187], v[100:103]
    v_mfma_f32_16x16x32_bf16 v[112:115], v[168:171], v[184:187], v[112:115]
    v_mfma_f32_16x16x32_bf16 v[116:119], v[172:175], v[184:187], v[116:119]
    v_cvt_pk_bf16_f32 v64, v64, v65
    v_cvt_pk_bf16_f32 v65, v66, v67
    v_mfma_f32_16x16x32_bf16 v[104:107], v[160:163], v[188:191], v[104:107]
    v_cvt_pk_bf16_f32 v66, v68, v69
    v_cvt_pk_bf16_f32 v67, v70, v71
    v_mfma_f32_16x16x32_bf16 v[108:111], v[164:167], v[188:191], v[108:111]
    v_cvt_pk_bf16_f32 v68, v72, v73
    v_cvt_pk_bf16_f32 v69, v74, v75
    v_mfma_f32_16x16x32_bf16 v[120:123], v[168:171], v[188:191], v[120:123]
    v_cvt_pk_bf16_f32 v70, v76, v77
    v_cvt_pk_bf16_f32 v71, v78, v79
    v_mfma_f32_16x16x32_bf16 v[124:127], v[172:175], v[188:191], v[124:127]
    v_permlane16_swap_b32 v64, v66
    v_permlane16_swap_b32 v65, v67
    v_mfma_f32_16x16x32_bf16 v[128:131], v[24:27], v[56:59], v[128:131]
    buffer_store_dwordx4 v[64:67], v206, s[32:35], s24 offen offset:0 sc1
    v_cvt_pk_bf16_f32 v72, v80, v81
    v_mfma_f32_16x16x32_bf16 v[132:135], v[28:31], v[56:59], v[132:135]
    v_cvt_pk_bf16_f32 v73, v82, v83
    v_cvt_pk_bf16_f32 v74, v84, v85
    v_mfma_f32_16x16x32_bf16 v[144:147], v[32:35], v[56:59], v[144:147]
    v_cvt_pk_bf16_f32 v75, v86, v87
    v_permlane16_swap_b32 v68, v70
    v_mfma_f32_16x16x32_bf16 v[148:151], v[36:39], v[56:59], v[148:151]
    v_permlane16_swap_b32 v69, v71
    buffer_store_dwordx4 v[68:71], v206, s[32:35], s24 offen offset:256 sc1
    v_mfma_f32_16x16x32_bf16 v[136:139], v[24:27], v[60:63], v[136:139]
    v_cvt_pk_bf16_f32 v76, v88, v89
    v_cvt_pk_bf16_f32 v77, v90, v91
    v_cvt_pk_bf16_f32 v78, v92, v93
    v_mfma_f32_16x16x32_bf16 v[140:143], v[28:31], v[60:63], v[140:143]
    v_cvt_pk_bf16_f32 v79, v94, v95
    v_permlane16_swap_b32 v72, v74
    v_permlane16_swap_b32 v73, v75
    v_mfma_f32_16x16x32_bf16 v[152:155], v[32:35], v[60:63], v[152:155]
    buffer_store_dwordx4 v[72:75], v206, s[32:35], s25 offen offset:0 sc1
    v_permlane16_swap_b32 v76, v78
    v_permlane16_swap_b32 v77, v79
    v_mfma_f32_16x16x32_bf16 v[156:159], v[36:39], v[60:63], v[156:159]
    buffer_store_dwordx4 v[76:79], v206, s[32:35], s25 offen offset:256 sc1
    v_cvt_pk_bf16_f32 v96, v96, v97
    v_cvt_pk_bf16_f32 v97, v98, v99
    v_mfma_f32_16x16x32_bf16 v[128:131], v[160:163], v[192:195], v[128:131]
    v_cvt_pk_bf16_f32 v98, v100, v101
    v_cvt_pk_bf16_f32 v99, v102, v103
    v_cvt_pk_bf16_f32 v100, v104, v105
    v_mfma_f32_16x16x32_bf16 v[132:135], v[164:167], v[192:195], v[132:135]
    v_cvt_pk_bf16_f32 v101, v106, v107
    v_cvt_pk_bf16_f32 v102, v108, v109
    v_cvt_pk_bf16_f32 v103, v110, v111
    v_mfma_f32_16x16x32_bf16 v[144:147], v[168:171], v[192:195], v[144:147]
    v_permlane16_swap_b32 v96, v98
    v_permlane16_swap_b32 v97, v99
    buffer_store_dwordx4 v[96:99], v206, s[32:35], s26 offen offset:0 sc1
    v_mfma_f32_16x16x32_bf16 v[148:151], v[172:175], v[192:195], v[148:151]
    v_cvt_pk_bf16_f32 v104, v112, v113
    v_cvt_pk_bf16_f32 v105, v114, v115
    v_cvt_pk_bf16_f32 v106, v116, v117
    v_mfma_f32_16x16x32_bf16 v[136:139], v[160:163], v[196:199], v[136:139]
    v_cvt_pk_bf16_f32 v107, v118, v119
    v_permlane16_swap_b32 v100, v102
    v_permlane16_swap_b32 v101, v103
    v_mfma_f32_16x16x32_bf16 v[140:143], v[164:167], v[196:199], v[140:143]
    buffer_store_dwordx4 v[100:103], v206, s[32:35], s26 offen offset:256 sc1
    v_cvt_pk_bf16_f32 v108, v120, v121
    v_cvt_pk_bf16_f32 v109, v122, v123
    v_mfma_f32_16x16x32_bf16 v[152:155], v[168:171], v[196:199], v[152:155]
    v_cvt_pk_bf16_f32 v110, v124, v125
    v_cvt_pk_bf16_f32 v111, v126, v127
    v_permlane16_swap_b32 v104, v106
    v_mfma_f32_16x16x32_bf16 v[156:159], v[172:175], v[196:199], v[156:159]
    v_permlane16_swap_b32 v105, v107
    buffer_store_dwordx4 v[104:107], v206, s[32:35], s27 offen offset:0 sc1
    v_permlane16_swap_b32 v108, v110
    v_permlane16_swap_b32 v109, v111
    buffer_store_dwordx4 v[108:111], v206, s[32:35], s27 offen offset:256 sc1
    v_cvt_pk_bf16_f32 v128, v128, v129
    v_cvt_pk_bf16_f32 v129, v130, v131
    v_cvt_pk_bf16_f32 v130, v132, v133
    v_cvt_pk_bf16_f32 v131, v134, v135
    v_cvt_pk_bf16_f32 v132, v136, v137
    v_cvt_pk_bf16_f32 v133, v138, v139
    v_cvt_pk_bf16_f32 v134, v140, v141
    v_cvt_pk_bf16_f32 v135, v142, v143
    v_permlane16_swap_b32 v128, v130
    v_permlane16_swap_b32 v129, v131
    buffer_store_dwordx4 v[128:131], v206, s[32:35], s28 offen offset:0 sc1
    v_cvt_pk_bf16_f32 v136, v144, v145
    v_cvt_pk_bf16_f32 v137, v146, v147
    v_cvt_pk_bf16_f32 v138, v148, v149
    v_cvt_pk_bf16_f32 v139, v150, v151
    v_permlane16_swap_b32 v132, v134
    v_permlane16_swap_b32 v133, v135
    buffer_store_dwordx4 v[132:135], v206, s[32:35], s28 offen offset:256 sc1
    v_cvt_pk_bf16_f32 v140, v152, v153
    v_cvt_pk_bf16_f32 v141, v154, v155
    v_cvt_pk_bf16_f32 v142, v156, v157
    v_cvt_pk_bf16_f32 v143, v158, v159
    v_permlane16_swap_b32 v136, v138
    v_permlane16_swap_b32 v137, v139
    buffer_store_dwordx4 v[136:139], v206, s[32:35], s29 offen offset:0 sc1
    v_permlane16_swap_b32 v140, v142
    v_permlane16_swap_b32 v141, v143
    buffer_store_dwordx4 v[140:143], v206, s[32:35], s29 offen offset:256 sc1
L_dA:
    s_waitcnt vmcnt(0)
    s_barrier
    s_cmp_eq_u32 s52, 0
    s_cbranch_scc0 L_k0
    s_mov_b32 s60, 14778496
    s_and_b64 exec, s[98:99], -1
    s_cbranch_scc0 L_nocnt
    buffer_atomic_add v13, v201, s[32:35], s60 offen sc1
L_nocnt:
    s_mov_b64 exec, 7
    buffer_store_dword v13, v200, s[32:35], s69 offen sc1
    s_mov_b64 exec, -1
    s_branch L_k0
L_sig0:
    s_and_b32 s61, s2, 31
    s_lshl_b32 s61, s61, 2
    s_mov_b64 exec, 1
    buffer_store_dword v13, v1, s[36:39], s61 offen sc1
    s_mov_b64 exec, -1
    s_branch L_p1l_B
.p2align 12
L_ld1:
    s_mov_b32 s32, s22
    s_mov_b32 s33, s23
    s_mov_b32 s34, 16777216
    s_mov_b32 s35, 0x20000
    s_mov_b32 s36, s20
    s_mov_b32 s37, s21
    s_mov_b32 s38, 256
    s_mov_b32 s39, 0x20000
    s_mov_b32 s40, s14
    s_mov_b32 s41, s15
    s_mov_b32 s42, 25088
    s_mov_b32 s43, 0x20000
    s_mov_b32 s48, s18
    s_mov_b32 s49, s19
    s_mov_b32 s50, 3670016
    s_mov_b32 s51, 0x20000
    s_mov_b32 s78, 0x3fb8aa3b
    s_mov_b32 s79, 0x3fb8aa3b
    s_mov_b32 s86, 0
    s_mov_b32 s87, -1
    s_lshr_b32 s58, s54, 4
    s_lshl_b32 s60, s53, 1
    s_add_u32 s58, s58, s60
    s_and_b32 s59, s54, 15
    s_and_b32 s80, s52, 3
    s_lshr_b32 s81, s52, 2
    s_mul_i32 s72, s53, 12288
    s_add_u32 s72, s72, 14680064
    s_mul_i32 s60, s54, 37
    s_lshr_b32 s60, s60, 8
    s_mul_i32 s61, s60, 7
    s_sub_u32 s83, s54, s61
    s_lshl_b32 s85, s53, 2
    s_add_u32 s85, s85, s60
    v_lshlrev_b32 v2, 4, v1
    v_lshrrev_b32 v3, 5, v1
    v_lshlrev_b32 v12, 7, v1
    v_mov_b32 v13, 1
    v_and_b32 v241, 3, v1
    v_lshlrev_b32 v241, 2, v241
    v_add_u32 v241, 161792, v241
    s_lshl_b32 s60, s80, 2
    s_add_u32 s60, s60, 161792
    v_mov_b32 v242, s60
    s_mov_b32 s44, s8
    s_mov_b32 s45, s9
    s_mov_b32 s46, 401408
    s_mov_b32 s47, 0x20000
    s_mov_b32 s96, s16
    s_mov_b32 s97, s17
    s_mov_b32 s98, 401408
    s_mov_b32 s99, 0x20000
    s_lshl_b32 s61, s80, 10
    s_cmp_eq_u32 s55, 0
    s_cbranch_scc1 L_nophi
    s_add_u32 m0, s61, 155648
    s_mul_i32 s62, s57, 3136
    s_add_u32 s62, s62, s61
    buffer_load_dwordx4 v2, s[40:43], s62 offen lds
L_nophi:
    s_cmp_lt_u32 s80, 2
    s_cbranch_scc0 L_ld2
    s_add_u32 m0, s61, 159744
    s_mul_i32 s62, s58, 1568
    s_add_u32 s62, s62, s61
    buffer_load_dwordx4 v2, s[40:43], s62 offen lds
    s_cmp_eq_u32 s52, 4
    s_cbranch_scc0 L_ld2
    v_lshlrev_b32 v5, 2, v1
    s_mov_b32 exec_hi, 0
    s_mov_b32 s82, 65536
L_poll_init:
    buffer_load_dword v4, v5, s[36:39], 0 offen sc1
    s_sub_u32 s82, s82, 1
    s_cmp_eq_u32 s82, 0
    s_waitcnt vmcnt(0)
    v_cmp_ne_u32 vcc, 1, v4
    s_cbranch_scc1 L_pollx_init
    s_cbranch_vccnz L_poll_init
L_pollx_init:
    s_mov_b64 exec, -1
L_ld2:
    s_waitcnt vmcnt(0)
    s_barrier
    v_lshrrev_b32 v4, 3, v1
    v_mul_u32_u24 v4, 896, v4
    v_lshrrev_b32 v5, 4, v1
    v_lshlrev_b32 v5, 1, v5
    v_and_b32 v6, 7, v1
    v_xor_b32 v5, v5, v6
    v_lshl_add_u32 v15, v5, 4, v4
    s_lshl_b32 s60, s58, 6
    s_add_u32 s60, s60, s80
    s_lshl_b32 s84, s60, 12
    s_add_u32 s84, s84, 2097152
    s_lshl_b32 s61, s59, 2
    s_add_u32 s69, s61, s60
    s_lshl_b32 s69, s69, 11
    s_lshl_b32 s92, s80, 12
    s_lshl_b32 s66, s80, 10
    s_sub_u32 s67, s84, s92
    s_add_u32 s67, s67, s66
    s_barrier
    s_lshl_b32 s60, s80, 11
    s_add_u32 m0, s60, 98304
    s_setprio 0
    v_bfe_u32 v4, v1, 2, 2
    v_bfe_u32 v5, v1, 4, 1
    v_and_b32 v6, 3, v1
    v_lshlrev_b32 v6, 3, v6
    v_lshl_add_u32 v6, v4, 7, v6
    v_lshl_add_u32 v6, v3, 11, v6
    v_lshrrev_b32 v4, 1, v4
    v_lshl_add_u32 v6, v4, 5, v6
    v_add_u32 v6, 98304, v6
    v_mul_u32_u24 v7, 576, v5
    v_add_u32 v32, v6, v7
    v_mul_u32_u24 v7, v7, v3
    v_sub_u32 v36, v32, v7
    v_xor_b32 v33, 32, v32
    v_xor_b32 v37, 32, v36
    v_xor_b32 v34, 64, v32
    v_xor_b32 v38, 64, v36
    v_xor_b32 v35, 96, v32
    v_xor_b32 v39, 96, v36
    s_lshr_b32 s60, s80, 1
    s_lshl_b32 s61, s85, 1
    s_add_u32 s60, s60, s61
    s_lshl_b32 s61, s60, 1
    s_add_u32 s61, s61, s81
    s_lshl_b32 s61, s61, 8
    s_add_u32 s24, s61, 14778368
    s_lshl_b32 s62, s81, 6
    s_add_u32 s60, s60, s62
    s_lshl_b32 s60, s60, 15
    s_and_b32 s62, s80, 1
    s_lshl_b32 s62, s62, 10
    s_add_u32 s60, s60, s62
    s_add_u32 s25, s60, 10485760
    s_xor_b32 s26, s25, 0x4000
    s_lshl_b32 s60, s52, 11
    s_add_u32 s60, s60, 81920
    v_and_b32 v4, 15, v1
    v_lshrrev_b32 v5, 4, v1
    v_and_b32 v6, 7, v1
    v_lshlrev_b32 v40, 4, v6
    v_lshl_add_u32 v40, v4, 7, v40
    v_lshlrev_b32 v5, 3, v5
    v_xor_b32 v40, v40, v5
    v_add_u32 v40, s60, v40
    v_lshrrev_b32 v4, 3, v1
    v_xor_b32 v44, v4, v6
    v_lshlrev_b32 v44, 4, v44
    v_lshl_add_u32 v44, v4, 7, v44
    v_add_u32 v44, s60, v44
    v_mul_u32_u24 v45, 1792, v4
    v_lshl_add_u32 v45, v6, 4, v45
    v_xor_b32 v41, 32, v40
    v_xor_b32 v42, 64, v40
    v_xor_b32 v43, 0x60, v40
    s_lshl_b32 s60, s85, 2
    s_add_u32 s60, s60, s80
    s_mul_i32 s60, s60, 28672
    s_mul_i32 s61, s81, 896
    s_add_u32 s60, s60, s61
    s_lshl_b32 s61, s83, 7
    s_add_u32 s28, s60, s61
    s_add_u32 s29, s28, 14336
    v_bfe_u32 v4, v1, 4, 1
    v_and_b32 v14, 15, v1
    v_lshlrev_b32 v14, 4, v14
    v_lshl_add_u32 v14, v4, 10, v14
    v_lshl_add_u32 v14, v3, 8, v14
    s_lshl_b32 s60, s59, 2
    s_add_u32 s60, s60, s80
    s_lshl_b32 s30, s60, 4
    s_and_b32 s31, s53, 6
    s_add_u32 s30, s30, s31
    s_and_b32 s31, s58, 1
    s_add_u32 s30, s30, s31
    s_and_b32 s31, s53, 1
    s_lshl_b32 s31, s31, 3
    s_add_u32 s30, s30, s31
    s_lshl_b32 s30, s30, 11
    s_lshl_b32 s31, s60, 9
    s_add_u32 s30, s30, 12582912
    s_add_u32 s31, s31, 14778624
    v_bfe_u32 v6, v1, 2, 2
    v_lshl_add_u32 v6, v3, 3, v6
    v_mul_u32_u24 v8, 56, v6
    v_bfe_u32 v6, v1, 4, 1
    v_and_b32 v7, 3, v1
    v_lshl_add_u32 v6, v6, 2, v7
    v_min_u32 v6, 6, v6
    v_lshl_add_u32 v8, v6, 3, v8
    v_add_u32 v8, 159744, v8
    v_bfe_u32 v4, v1, 1, 1
    v_and_b32 v5, 1, v1
    v_lshrrev_b32 v244, 2, v1
    v_lshlrev_b32 v244, 4, v244
    v_lshl_add_u32 v244, v4, 10, v244
    v_lshl_add_u32 v244, v5, 3, v244
    v_mov_b32 v245, 0xdddddddd
    v_bfe_u32 v4, v1, 2, 2
    v_lshl_add_u32 v5, v3, 3, v4
    v_lshrrev_b32 v6, 1, v4
    v_bfe_u32 v7, v1, 4, 1
    v_and_b32 v4, 2, v1
    v_or_b32 v7, v7, v4
    v_xor_b32 v6, v6, v7
    v_lshlrev_b32 v6, 4, v6
    v_lshl_add_u32 v5, v5, 6, v6
    v_and_b32 v4, 1, v1
    v_lshl_add_u32 v5, v4, 3, v5
    s_lshl_b32 s60, s80, 13
    s_add_u32 s60, s60, 106496
    v_add_u32 v204, s60, v5
    v_add_u32 v247, s60, v2
    v_xor_b32 v205, 32, v204
    s_lshr_b32 s62, s80, 1
    s_lshl_b32 s60, s62, 13
    s_add_u32 s60, s60, 139264
    v_add_u32 v246, s60, v2
    s_lshl_b32 s60, s57, 1
    s_add_u32 s60, s60, s62
    s_lshl_b32 s60, s60, 4
    s_add_u32 s60, s60, s56
    s_lshl_b32 s60, s60, 1
    s_and_b32 s61, s80, 1
    s_add_u32 s60, s60, s61
    s_lshl_b32 s60, s60, 12
    s_add_u32 s68, s60, 8388608
    v_mov_b64 v[80:81], 0
    v_mov_b64 v[82:83], 0
    v_mov_b64 v[84:85], 0
    v_mov_b64 v[86:87], 0
    v_mov_b64 v[88:89], 0
    v_mov_b64 v[90:91], 0
    v_mov_b64 v[92:93], 0
    v_mov_b64 v[94:95], 0
    v_mov_b64 v[96:97], 0
    v_mov_b64 v[98:99], 0
    v_mov_b64 v[100:101], 0
    v_mov_b64 v[102:103], 0
    v_mov_b64 v[104:105], 0
    v_mov_b64 v[106:107], 0
    v_mov_b64 v[108:109], 0
    v_mov_b64 v[110:111], 0
    ds_read_b64_tr_b16 v[16:17], v8 offset:0
    ds_read_b64_tr_b16 v[18:19], v8 offset:896
    ds_read_b64_tr_b16 v[20:21], v8 offset:224
    ds_read_b64_tr_b16 v[22:23], v8 offset:1120
    s_setprio 3
    s_cmp_eq_u32 s55, 0
    s_cbranch_scc0 L_noD
    s_barrier
L_noD:
    s_lshl_b32 s61, 1, s59
    s_or_b32 exec_lo, s61, 808452096
    s_mov_b32 exec_hi, 12336
    s_lshl_b32 s61, s53, 4
    s_add_u32 s61, s61, s59
    s_lshl_b32 s61, s61, 8
    s_add_u32 s61, s61, 14778496
    s_mov_b64 exec, 1
    s_mov_b32 s82, 65536
L_poll_s1:
    v_mov_b32 v240, 0
    s_sub_u32 s82, s82, 1
    buffer_atomic_add v240, v1, s[32:35], s61 offen sc0 sc1
    s_cmp_eq_u32 s82, 0
    s_waitcnt vmcnt(0)
    v_cmp_ne_u32 vcc, 9, v240
    s_cbranch_scc1 L_pollx_s1
    s_cbranch_vccnz L_poll_s1
L_pollx_s1:
    s_mov_b64 exec, -1
    s_mov_b64 exec, -1
L_go:
    buffer_load_dwordx4 v2, s[32:35], s69 offen sc1 lds
    buffer_load_dwordx4 v2, s[32:35], s69 offen offset:1024 sc1 lds
    s_add_u32 m0, s66, 32768
    s_add_u32 s62, s67, 65536
    buffer_load_dwordx4 v2, s[32:35], s62 offen sc1 lds
    s_add_u32 m0, s66, 49152
    s_add_u32 s62, s67, 196608
    buffer_load_dwordx4 v2, s[32:35], s62 offen sc1 lds
    s_add_u32 m0, s66, 36864
    s_add_u32 s62, s67, 69632
    buffer_load_dwordx4 v2, s[32:35], s62 offen sc1 lds
    s_add_u32 m0, s66, 53248
    s_add_u32 s62, s67, 200704
    buffer_load_dwordx4 v2, s[32:35], s62 offen sc1 lds
    s_add_u32 m0, s66, 40960
    s_add_u32 s62, s67, 73728
    buffer_load_dwordx4 v2, s[32:35], s62 offen sc1 lds
    s_add_u32 m0, s66, 57344
    s_add_u32 s62, s67, 204800
    buffer_load_dwordx4 v2, s[32:35], s62 offen sc1 lds
    s_add_u32 m0, s66, 45056
    s_add_u32 s62, s67, 77824
    buffer_load_dwordx4 v2, s[32:35], s62 offen sc1 lds
    s_add_u32 m0, s66, 61440
    s_add_u32 s62, s67, 208896
    buffer_load_dwordx4 v2, s[32:35], s62 offen sc1 lds
    s_waitcnt vmcnt(4) lgkmcnt(0)
    s_barrier
L_svc0:
    s_add_u32 m0, s92, 65536
    s_add_u32 s62, s84, 81920
    buffer_load_dwordx4 v2, s[32:35], s62 offen offset:0 sc1 lds
    buffer_load_dwordx4 v2, s[32:35], s62 offen offset:1024 sc1 lds
    buffer_load_dwordx4 v2, s[32:35], s62 offen offset:2048 sc1 lds
    buffer_load_dwordx4 v2, s[32:35], s62 offen offset:3072 sc1 lds
    s_waitcnt vmcnt(4)
    ds_write_b32 v242, v13 offset:48
    s_add_u32 m0, s92, 81920
    s_add_u32 s62, s84, 212992
    buffer_load_dwordx4 v2, s[32:35], s62 offen offset:0 sc1 lds
    buffer_load_dwordx4 v2, s[32:35], s62 offen offset:1024 sc1 lds
    buffer_load_dwordx4 v2, s[32:35], s62 offen offset:2048 sc1 lds
    buffer_load_dwordx4 v2, s[32:35], s62 offen offset:3072 sc1 lds
    s_mov_b32 exec_lo, 0xffff0000
    s_mov_b32 exec_hi, 0xffff
    buffer_load_dword v240, v12, s[32:35], s72 offen sc1
    s_mov_b64 exec, -1
    ds_read_b128 v[128:131], v247 offset:0
    ds_read_b128 v[132:135], v247 offset:1024
    ds_read_b128 v[136:139], v247 offset:2048
    ds_read_b128 v[140:143], v247 offset:3072
    s_waitcnt vmcnt(1)
    ds_write_b32 v242, v13 offset:80
    s_mov_b32 exec_lo, 0xffff0000
    s_mov_b32 exec_hi, 0xffff
    s_waitcnt vmcnt(0)
    v_cmp_ne_u32 vcc, 1, v240
    s_mov_b32 s82, 65536
    s_cbranch_vccnz L_poll_s1b
L_pollx_s1b:
    s_mov_b64 exec, -1
    s_add_u32 m0, s92, 0
    s_add_u32 s62, s84, 98304
    buffer_load_dwordx4 v2, s[32:35], s62 offen offset:0 sc1 lds
    buffer_load_dwordx4 v2, s[32:35], s62 offen offset:1024 sc1 lds
    buffer_load_dwordx4 v2, s[32:35], s62 offen offset:2048 sc1 lds
    buffer_load_dwordx4 v2, s[32:35], s62 offen offset:3072 sc1 lds
    s_add_u32 m0, s92, 16384
    s_add_u32 s62, s84, 229376
    buffer_load_dwordx4 v2, s[32:35], s62 offen offset:0 sc1 lds
    buffer_load_dwordx4 v2, s[32:35], s62 offen offset:1024 sc1 lds
    buffer_load_dwordx4 v2, s[32:35], s62 offen offset:2048 sc1 lds
    buffer_load_dwordx4 v2, s[32:35], s62 offen offset:3072 sc1 lds
    s_cmp_eq_u32 s55, 1
    s_cbranch_scc0 L_g_kvs2
    s_waitcnt lgkmcnt(0)
    buffer_store_dwordx4 v[128:131], v2, s[32:35], s68 offen offset:0 sc1
    buffer_store_dwordx4 v[132:135], v2, s[32:35], s68 offen offset:1024 sc1
    buffer_store_dwordx4 v[136:139], v2, s[32:35], s68 offen offset:2048 sc1
    buffer_store_dwordx4 v[140:143], v2, s[32:35], s68 offen offset:3072 sc1
    s_waitcnt vmcnt(4)
    ds_write_b32 v242, v13 offset:96
L_g_kvs2:
    s_waitcnt vmcnt(0)
    ds_write_b32 v242, v13 offset:96
    ds_write_b32 v242, v13 offset:400
    s_xor_b32 s60, s80, 1
    s_cmp_lt_u32 s60, s55
    s_cbranch_scc0 L_g_sfb
    s_mov_b32 s82, 1048576
L_lw_fb:
    ds_read_b32 v243, v241 offset:400
    s_sub_u32 s82, s82, 1
    s_waitcnt lgkmcnt(0)
    v_cmp_ne_u32 vcc, 1, v243
    s_cmp_eq_u32 s82, 0
    s_cbranch_scc1 L_lwx_fb
    s_cbranch_vccnz L_lw_fb
L_lwx_fb:
    s_mul_i32 s60, s57, 12288
    s_lshl_b32 s61, s56, 7
    s_add_u32 s60, s60, s61
    s_add_u32 s60, s60, 14686208
    s_mov_b64 exec, 1
    buffer_store_dword v13, v1, s[32:35], s60 offen sc1
    s_mov_b64 exec, -1
L_g_sfb:
    s_mov_b32 s82, 1048576
L_lw_c1:
    ds_read_b32 v243, v241 offset:256
    s_sub_u32 s82, s82, 1
    s_waitcnt lgkmcnt(0)
    v_cmp_ne_u32 vcc, 1, v243
    s_cmp_eq_u32 s82, 0
    s_cbranch_scc1 L_lwx_c1
    s_cbranch_vccnz L_lws_c1
L_lwx_c1:
    s_add_u32 m0, s92, 32768
    s_add_u32 s62, s84, 114688
    buffer_load_dwordx4 v2, s[32:35], s62 offen offset:0 sc1 lds
    buffer_load_dwordx4 v2, s[32:35], s62 offen offset:1024 sc1 lds
    buffer_load_dwordx4 v2, s[32:35], s62 offen offset:2048 sc1 lds
    buffer_load_dwordx4 v2, s[32:35], s62 offen offset:3072 sc1 lds
    s_add_u32 m0, s92, 49152
    s_add_u32 s62, s84, 245760
    buffer_load_dwordx4 v2, s[32:35], s62 offen offset:0 sc1 lds
    buffer_load_dwordx4 v2, s[32:35], s62 offen offset:1024 sc1 lds
    buffer_load_dwordx4 v2, s[32:35], s62 offen offset:2048 sc1 lds
    buffer_load_dwordx4 v2, s[32:35], s62 offen offset:3072 sc1 lds
    s_mov_b32 s82, 1048576
L_lw_r2:
    ds_read_b32 v243, v241 offset:96
    s_sub_u32 s82, s82, 1
    s_waitcnt lgkmcnt(0)
    v_cmp_ne_u32 vcc, 1, v243
    s_cmp_eq_u32 s82, 0
    s_cbranch_scc1 L_lwx_r2
    s_cbranch_vccnz L_lws_r2
L_lwx_r2:
    s_waitcnt vmcnt(0)
    ds_write_b32 v242, v13 offset:112
    s_mul_i32 s63, s80, 7168
    s_mul_i32 s64, s80, 50176
    s_lshl_b32 s65, s83, 7
    s_add_u32 s64, s64, s65
    s_add_u32 m0, s63, 126976
    s_add_u32 s65, s64, 200704
    buffer_load_dwordx4 v15, s[96:99], s65 offen offset:0 lds
    s_add_u32 s65, s64, 206848
    buffer_load_dwordx4 v15, s[96:99], s65 offen offset:1024 lds
    s_add_u32 s65, s64, 212992
    buffer_load_dwordx4 v15, s[96:99], s65 offen offset:2048 lds
    s_add_u32 s65, s64, 219136
    buffer_load_dwordx4 v15, s[96:99], s65 offen offset:3072 lds
    s_add_u32 m0, s63, 131072
    s_add_u32 s65, s64, 229376
    buffer_load_dwordx4 v15, s[96:99], s65 offen offset:0 lds
    s_add_u32 s65, s64, 235520
    buffer_load_dwordx4 v15, s[96:99], s65 offen offset:1024 lds
    s_add_u32 s65, s64, 241664
    buffer_load_dwordx4 v15, s[96:99], s65 offen offset:2048 lds
    v_mov_b64 v[4:5], -1
    v_mov_b64 v[6:7], -1
    s_sub_u32 s60, s30, 0x200000
    buffer_store_dwordx4 v[4:7], v2, s[32:35], s60 offen sc1
    buffer_store_dwordx4 v[4:7], v2, s[32:35], s60 offen offset:1024 sc1
    s_mov_b32 s82, 1048576
L_lw_c2:
    ds_read_b32 v243, v241 offset:272
    s_sub_u32 s82, s82, 1
    s_waitcnt lgkmcnt(0)
    v_cmp_ne_u32 vcc, 1, v243
    s_cmp_eq_u32 s82, 0
    s_cbranch_scc1 L_lwx_c2
    s_cbranch_vccnz L_lws_c2
L_lwx_c2:
    s_add_u32 m0, s92, 65536
    s_add_u32 s62, s84, 0
    buffer_load_dwordx4 v2, s[32:35], s62 offen offset:0 sc1 lds
    buffer_load_dwordx4 v2, s[32:35], s62 offen offset:1024 sc1 lds
    buffer_load_dwordx4 v2, s[32:35], s62 offen offset:2048 sc1 lds
    buffer_load_dwordx4 v2, s[32:35], s62 offen offset:3072 sc1 lds
    s_add_u32 m0, s92, 81920
    s_add_u32 s62, s84, 131072
    buffer_load_dwordx4 v2, s[32:35], s62 offen offset:0 sc1 lds
    buffer_load_dwordx4 v2, s[32:35], s62 offen offset:1024 sc1 lds
    buffer_load_dwordx4 v2, s[32:35], s62 offen offset:2048 sc1 lds
    buffer_load_dwordx4 v2, s[32:35], s62 offen offset:3072 sc1 lds
    s_add_u32 s60, s72, 6144
    s_mov_b64 exec, 0xffff
    buffer_load_dword v240, v12, s[32:35], s60 offen sc1
    s_waitcnt vmcnt(0)
    ds_write_b32 v242, v13 offset:128
    v_cmp_ne_u32 vcc, 1, v240
    s_mov_b32 s82, 65536
    s_cbranch_vccnz L_poll_fb
L_pollx_fb:
    s_mov_b64 exec, -1
    s_add_u32 s60, s69, 6291456
    buffer_load_dwordx4 v[24:27], v2, s[32:35], s60 offen sc1
    buffer_load_dwordx4 v[28:31], v2, s[32:35], s60 offen offset:1024 sc1
    s_cmp_eq_u32 s80, 0
    s_cbranch_scc0 L_g_sl1
    s_lshr_b32 s60, s59, 2
    s_lshl_b32 s60, s60, 11
    s_and_b32 s61, s59, 3
    s_lshl_b32 s61, s61, 8
    s_add_u32 s60, s60, s61
    s_lshl_b32 s61, s58, 17
    s_add_u32 s60, s60, s61
    s_add_u32 s60, s60, 8388608
    buffer_load_dwordx2 v[48:49], v244, s[32:35], s60 offen sc1
    s_add_u32 s60, s60, 8192
    buffer_load_dwordx2 v[50:51], v244, s[32:35], s60 offen sc1
    s_add_u32 s60, s60, 8192
    buffer_load_dwordx2 v[52:53], v244, s[32:35], s60 offen sc1
    s_add_u32 s60, s60, 8192
    buffer_load_dwordx2 v[54:55], v244, s[32:35], s60 offen sc1
    s_add_u32 s60, s60, 8192
    buffer_load_dwordx2 v[56:57], v244, s[32:35], s60 offen sc1
    s_add_u32 s60, s60, 8192
    buffer_load_dwordx2 v[58:59], v244, s[32:35], s60 offen sc1
    s_add_u32 s60, s60, 8192
    buffer_load_dwordx2 v[60:61], v244, s[32:35], s60 offen sc1
    s_add_u32 s60, s60, 8192
    buffer_load_dwordx2 v[62:63], v244, s[32:35], s60 offen sc1
    s_add_u32 s60, s60, 8192
    buffer_load_dwordx2 v[64:65], v244, s[32:35], s60 offen sc1
    s_add_u32 s60, s60, 8192
    buffer_load_dwordx2 v[66:67], v244, s[32:35], s60 offen sc1
    s_add_u32 s60, s60, 8192
    buffer_load_dwordx2 v[68:69], v244, s[32:35], s60 offen sc1
    s_add_u32 s60, s60, 8192
    buffer_load_dwordx2 v[70:71], v244, s[32:35], s60 offen sc1
    s_add_u32 s60, s60, 8192
    buffer_load_dwordx2 v[72:73], v244, s[32:35], s60 offen sc1
    s_add_u32 s60, s60, 8192
    buffer_load_dwordx2 v[74:75], v244, s[32:35], s60 offen sc1
    s_add_u32 s60, s60, 8192
    buffer_load_dwordx2 v[76:77], v244, s[32:35], s60 offen sc1
    s_add_u32 s60, s60, 8192
    buffer_load_dwordx2 v[78:79], v244, s[32:35], s60 offen sc1
L_g_sl1:
    s_mov_b32 s82, 1048576
L_lw_c3:
    ds_read_b32 v243, v241 offset:288
    s_sub_u32 s82, s82, 1
    s_waitcnt lgkmcnt(0)
    v_cmp_ne_u32 vcc, 1, v243
    s_cmp_eq_u32 s82, 0
    s_cbranch_scc1 L_lwx_c3
    s_cbranch_vccnz L_lws_c3
L_lwx_c3:
    s_add_u32 m0, s92, 0
    s_add_u32 s62, s84, 16384
    buffer_load_dwordx4 v2, s[32:35], s62 offen offset:0 sc1 lds
    buffer_load_dwordx4 v2, s[32:35], s62 offen offset:1024 sc1 lds
    buffer_load_dwordx4 v2, s[32:35], s62 offen offset:2048 sc1 lds
    buffer_load_dwordx4 v2, s[32:35], s62 offen offset:3072 sc1 lds
    s_add_u32 m0, s92, 16384
    s_add_u32 s62, s84, 147456
    buffer_load_dwordx4 v2, s[32:35], s62 offen offset:0 sc1 lds
    buffer_load_dwordx4 v2, s[32:35], s62 offen offset:1024 sc1 lds
    buffer_load_dwordx4 v2, s[32:35], s62 offen offset:2048 sc1 lds
    buffer_load_dwordx4 v2, s[32:35], s62 offen offset:3072 sc1 lds
    s_waitcnt vmcnt(8)
    v_mfma_f32_32x32x16_bf16 v[112:127], v[16:19], v[24:27], 0
    v_mfma_f32_32x32x16_bf16 v[112:127], v[20:23], v[28:31], v[112:127]
    s_cmp_eq_u32 s80, 0
    s_cbranch_scc0 L_g_sl2
    v_add_f32 v48, v48, v64
    v_add_f32 v49, v49, v65
    v_add_f32 v50, v50, v66
    v_add_f32 v51, v51, v67
    v_add_f32 v52, v52, v68
    v_add_f32 v53, v53, v69
    v_add_f32 v54, v54, v70
    v_add_f32 v55, v55, v71
    v_add_f32 v56, v56, v72
    v_add_f32 v57, v57, v73
    v_add_f32 v58, v58, v74
    v_add_f32 v59, v59, v75
    v_add_f32 v60, v60, v76
    v_add_f32 v61, v61, v77
    v_add_f32 v62, v62, v78
    v_add_f32 v63, v63, v79
    v_add_f32 v48, v48, v56
    v_add_f32 v49, v49, v57
    v_add_f32 v50, v50, v58
    v_add_f32 v51, v51, v59
    v_add_f32 v52, v52, v60
    v_add_f32 v53, v53, v61
    v_add_f32 v54, v54, v62
    v_add_f32 v55, v55, v63
    v_add_f32 v48, v48, v52
    v_add_f32 v49, v49, v53
    v_add_f32 v50, v50, v54
    v_add_f32 v51, v51, v55
    v_add_f32 v48, v48, v50
    v_add_f32 v49, v49, v51
    s_lshl_b32 s60, s58, 4
    s_add_u32 s60, s60, s59
    s_lshl_b32 s60, s60, 8
    s_add_u32 s60, s60, 15204352
    v_cvt_pk_bf16_f32 v48, v48, v49
    v_lshlrev_b32 v244, 2, v1
    s_bitcmp1_b32 s59, 0
    s_cselect_b32 exec_hi, 0x00f00000, 0
    s_and_b32 s61, s59, 7
    s_cmp_eq_u32 s61, 7
    s_cselect_b32 exec_hi, 0x00300000, exec_hi
    s_mov_b32 exec_lo, 0
    v_mov_b32 v48, 0x3f803f80
    s_mov_b64 exec, -1
    s_waitcnt vmcnt(0)
    buffer_store_dword v48, v244, s[32:35], s60 offen sc1
    ds_write_b32 v242, v13 offset:144
L_g_sl2:
    s_nop 9
    v_max3_f32 v8, v112, v113, v114
    v_max3_f32 v10, -v112, -v113, -v114
    v_max3_f32 v8, v8, v115, v116
    v_max3_f32 v10, v10, -v115, -v116
    v_max3_f32 v8, v8, v117, v118
    v_max3_f32 v10, v10, -v117, -v118
    v_max3_f32 v8, v8, v119, v120
    v_max3_f32 v10, v10, -v119, -v120
    v_max3_f32 v8, v8, v121, v122
    v_max3_f32 v10, v10, -v121, -v122
    v_max3_f32 v8, v8, v123, v124
    v_max3_f32 v10, v10, -v123, -v124
    v_max3_f32 v8, v8, v125, v126
    v_max3_f32 v10, v10, -v125, -v126
    v_max_f32 v8, v8, v127
    v_max_f32_e64 v10, v10, -v127
    s_nop 1
    v_permlane32_swap_b32 v8, v10
    v_max_f32 v8, v8, v10
    v_mul_f32_e64 v10, -v8, s78
    v_mul_f32_e64 v8, -v8, s78
    s_nop 1
    v_permlane32_swap_b32 v8, v10
    v_fma_f32 v48, v112, s78, v8
    v_fma_f32 v64, -v112, s78, v10
    v_fma_f32 v49, v113, s78, v8
    v_fma_f32 v65, -v113, s78, v10
    v_fma_f32 v50, v114, s78, v8
    v_fma_f32 v66, -v114, s78, v10
    v_fma_f32 v51, v115, s78, v8
    v_fma_f32 v67, -v115, s78, v10
    v_fma_f32 v52, v116, s78, v8
    v_fma_f32 v68, -v116, s78, v10
    v_fma_f32 v53, v117, s78, v8
    v_fma_f32 v69, -v117, s78, v10
    v_fma_f32 v54, v118, s78, v8
    v_fma_f32 v70, -v118, s78, v10
    v_fma_f32 v55, v119, s78, v8
    v_fma_f32 v71, -v119, s78, v10
    v_fma_f32 v56, v120, s78, v8
    v_fma_f32 v72, -v120, s78, v10
    v_fma_f32 v57, v121, s78, v8
    v_fma_f32 v73, -v121, s78, v10
    v_fma_f32 v58, v122, s78, v8
    v_fma_f32 v74, -v122, s78, v10
    v_fma_f32 v59, v123, s78, v8
    v_fma_f32 v75, -v123, s78, v10
    v_fma_f32 v60, v124, s78, v8
    v_fma_f32 v76, -v124, s78, v10
    v_fma_f32 v61, v125, s78, v8
    v_fma_f32 v77, -v125, s78, v10
    v_fma_f32 v62, v126, s78, v8
    v_fma_f32 v78, -v126, s78, v10
    v_fma_f32 v63, v127, s78, v8
    v_fma_f32 v79, -v127, s78, v10
    s_waitcnt vmcnt(0)
    ds_write_b32 v242, v13 offset:144
    s_cmp_eq_u32 s80, 0
    s_cbranch_scc0 L_g_sfk
    s_lshl_b32 s60, s54, 7
    s_add_u32 s60, s60, s72
    s_add_u32 s60, s60, 8192
    s_mov_b64 exec, 1
    buffer_store_dword v13, v1, s[32:35], s60 offen sc1
    s_mov_b64 exec, -1
L_g_sfk:
    s_mov_b32 s82, 1048576
L_lw_c4:
    ds_read_b32 v243, v241 offset:304
    s_sub_u32 s82, s82, 1
    s_waitcnt lgkmcnt(0)
    v_cmp_ne_u32 vcc, 1, v243
    s_cmp_eq_u32 s82, 0
    s_cbranch_scc1 L_lwx_c4
    s_cbranch_vccnz L_lws_c4
L_lwx_c4:
    s_add_u32 m0, s92, 32768
    s_add_u32 s62, s84, 32768
    buffer_load_dwordx4 v2, s[32:35], s62 offen offset:0 sc1 lds
    buffer_load_dwordx4 v2, s[32:35], s62 offen offset:1024 sc1 lds
    buffer_load_dwordx4 v2, s[32:35], s62 offen offset:2048 sc1 lds
    buffer_load_dwordx4 v2, s[32:35], s62 offen offset:3072 sc1 lds
    s_add_u32 m0, s92, 49152
    s_add_u32 s62, s84, 163840
    buffer_load_dwordx4 v2, s[32:35], s62 offen offset:0 sc1 lds
    buffer_load_dwordx4 v2, s[32:35], s62 offen offset:1024 sc1 lds
    buffer_load_dwordx4 v2, s[32:35], s62 offen offset:2048 sc1 lds
    buffer_load_dwordx4 v2, s[32:35], s62 offen offset:3072 sc1 lds
    v_exp_f32 v48, v48
    v_exp_f32 v49, v49
    v_exp_f32 v50, v50
    v_exp_f32 v51, v51
    v_exp_f32 v52, v52
    v_exp_f32 v53, v53
    v_exp_f32 v54, v54
    v_exp_f32 v55, v55
    v_exp_f32 v56, v56
    v_exp_f32 v57, v57
    v_exp_f32 v58, v58
    v_exp_f32 v59, v59
    v_exp_f32 v60, v60
    v_exp_f32 v61, v61
    v_exp_f32 v62, v62
    v_exp_f32 v63, v63
    v_exp_f32 v64, v64
    v_exp_f32 v65, v65
    v_exp_f32 v66, v66
    v_exp_f32 v67, v67
    v_exp_f32 v68, v68
    v_exp_f32 v69, v69
    v_exp_f32 v70, v70
    v_exp_f32 v71, v71
    v_exp_f32 v72, v72
    v_exp_f32 v73, v73
    v_exp_f32 v74, v74
    v_exp_f32 v75, v75
    v_exp_f32 v76, v76
    v_exp_f32 v77, v77
    v_exp_f32 v78, v78
    v_exp_f32 v79, v79
    s_and_b32 s60, s54, 16
    s_lshl_b32 s60, s60, 7
    s_add_u32 s60, s60, s72
    s_add_u32 s60, s60, 8192
    s_waitcnt vmcnt(0)
    ds_write_b32 v242, v13 offset:160
    s_mov_b32 s82, 1048576
L_lw_c5:
    ds_read_b32 v243, v241 offset:320
    s_sub_u32 s82, s82, 1
    s_waitcnt lgkmcnt(0)
    v_cmp_ne_u32 vcc, 1, v243
    s_cmp_eq_u32 s82, 0
    s_cbranch_scc1 L_lwx_c5
    s_cbranch_vccnz L_lws_c5
L_lwx_c5:
    s_add_u32 m0, s92, 65536
    s_add_u32 s62, s84, 49152
    buffer_load_dwordx4 v2, s[32:35], s62 offen offset:0 sc1 lds
    buffer_load_dwordx4 v2, s[32:35], s62 offen offset:1024 sc1 lds
    buffer_load_dwordx4 v2, s[32:35], s62 offen offset:2048 sc1 lds
    buffer_load_dwordx4 v2, s[32:35], s62 offen offset:3072 sc1 lds
    s_add_u32 m0, s92, 81920
    s_add_u32 s62, s84, 180224
    buffer_load_dwordx4 v2, s[32:35], s62 offen offset:0 sc1 lds
    buffer_load_dwordx4 v2, s[32:35], s62 offen offset:1024 sc1 lds
    buffer_load_dwordx4 v2, s[32:35], s62 offen offset:2048 sc1 lds
    buffer_load_dwordx4 v2, s[32:35], s62 offen offset:3072 sc1 lds
    s_mov_b64 exec, 0xffff
    buffer_load_dword v240, v12, s[32:35], s60 offen sc1
    s_waitcnt vmcnt(0)
    ds_write_b32 v242, v13 offset:176
    v_cmp_ne_u32 vcc, 1, v240
    s_mov_b32 s82, 65536
    s_cbranch_vccnz L_poll_fk
L_pollx_fk:
    s_mov_b64 exec, -1
    s_lshl_b32 s60, s58, 12
    s_add_u32 s60, s60, 15204352
    buffer_load_dwordx4 v[16:19], v2, s[32:35], s60 offen offset:0 sc1
    buffer_load_dwordx4 v[20:23], v2, s[32:35], s60 offen offset:1024 sc1
    buffer_load_dwordx4 v[24:27], v2, s[32:35], s60 offen offset:2048 sc1
    buffer_load_dwordx4 v[28:31], v2, s[32:35], s60 offen offset:3072 sc1
    s_mul_i32 s63, s80, 7168
    s_mul_i32 s64, s80, 50176
    s_lshl_b32 s65, s83, 7
    s_add_u32 s64, s64, s65
    s_add_u32 m0, s63, 98304
    s_add_u32 s65, s64, 0
    buffer_load_dwordx4 v15, s[96:99], s65 offen offset:0 lds
    s_add_u32 s65, s64, 6144
    buffer_load_dwordx4 v15, s[96:99], s65 offen offset:1024 lds
    s_add_u32 s65, s64, 12288
    buffer_load_dwordx4 v15, s[96:99], s65 offen offset:2048 lds
    s_add_u32 s65, s64, 18432
    buffer_load_dwordx4 v15, s[96:99], s65 offen offset:3072 lds
    s_add_u32 m0, s63, 102400
    s_add_u32 s65, s64, 28672
    buffer_load_dwordx4 v15, s[96:99], s65 offen offset:0 lds
    s_add_u32 s65, s64, 34816
    buffer_load_dwordx4 v15, s[96:99], s65 offen offset:1024 lds
    s_add_u32 s65, s64, 40960
    buffer_load_dwordx4 v15, s[96:99], s65 offen offset:2048 lds
    s_waitcnt vmcnt(7)
    v_smfmac_f32_32x32x32_bf16 v[80:95], v[16:19], v[48:55], v245
    v_smfmac_f32_32x32x32_bf16 v[80:95], v[20:23], v[56:63], v245
    v_smfmac_f32_32x32x32_bf16 v[96:111], v[24:27], v[64:71], v245
    v_smfmac_f32_32x32x32_bf16 v[96:111], v[28:31], v[72:79], v245
    v_mov_b32 v4, 0x358637bd
    s_nop 8
    v_rcp_f32 v8, v93
    s_nop 0
    v_rcp_f32 v10, v109
    v_fmac_f32 v4, v92, v8
    v_fmac_f32 v4, v108, v10
    v_rcp_f32 v4, v4
    s_nop 0
    v_mul_f32 v8, v8, v4
    v_mul_f32 v10, v10, v4
    v_mov_b32 v4, v8
    v_mov_b32 v5, v10
    s_nop 0
    v_permlane32_swap_b32 v4, v8
    v_permlane32_swap_b32 v5, v10
    v_mul_f32 v80, v80, v8
    v_mul_f32 v81, v81, v8
    v_mul_f32 v82, v82, v8
    v_mul_f32 v83, v83, v8
    v_mul_f32 v84, v84, v8
    v_mul_f32 v85, v85, v8
    v_mul_f32 v86, v86, v8
    v_mul_f32 v87, v87, v8
    v_mul_f32 v88, v88, v8
    v_mul_f32 v89, v89, v8
    v_mul_f32 v90, v90, v8
    v_mul_f32 v91, v91, v8
    v_mul_f32 v92, v92, v8
    v_mul_f32 v93, v93, v8
    v_mul_f32 v94, v94, v8
    v_mul_f32 v95, v95, v8
    v_fmac_f32 v80, v96, v10
    v_fmac_f32 v81, v97, v10
    v_fmac_f32 v82, v98, v10
    v_fmac_f32 v83, v99, v10
    v_fmac_f32 v84, v100, v10
    v_fmac_f32 v85, v101, v10
    v_fmac_f32 v86, v102, v10
    v_fmac_f32 v87, v103, v10
    v_fmac_f32 v88, v104, v10
    v_fmac_f32 v89, v105, v10
    v_fmac_f32 v90, v106, v10
    v_fmac_f32 v91, v107, v10
    v_fmac_f32 v92, v108, v10
    v_fmac_f32 v93, v109, v10
    v_fmac_f32 v94, v110, v10
    v_fmac_f32 v95, v111, v10
    v_cvt_pk_bf16_f32 v64, v80, v81
    v_cvt_pk_bf16_f32 v65, v82, v83
    v_cvt_pk_bf16_f32 v66, v84, v85
    v_cvt_pk_bf16_f32 v67, v86, v87
    v_cvt_pk_bf16_f32 v68, v88, v89
    v_cvt_pk_bf16_f32 v69, v90, v91
    v_cvt_pk_bf16_f32 v70, v92, v93
    v_cvt_pk_bf16_f32 v71, v94, v95
    s_mov_b64 exec, s[86:87]
    v_mov_b32 v70, 0
    s_mov_b64 exec, -1
    buffer_store_dwordx4 v[64:67], v14, s[32:35], s30 offen sc1
    buffer_store_dwordx4 v[68:71], v14, s[32:35], s30 offen offset:512 sc1
    s_mov_b32 s82, 1048576
L_lw_c6:
    ds_read_b32 v243, v241 offset:336
    s_sub_u32 s82, s82, 1
    s_waitcnt lgkmcnt(0)
    v_cmp_ne_u32 vcc, 1, v243
    s_cmp_eq_u32 s82, 0
    s_cbranch_scc1 L_lwx_c6
    s_cbranch_vccnz L_lws_c6
L_lwx_c6:
    s_mul_i32 s63, s80, 8192
    s_mul_i32 s64, s80, 57344
    s_lshl_b32 s65, s83, 7
    s_add_u32 s64, s64, s65
    s_add_u32 m0, s63, 0
    s_add_u32 s65, s64, 0
    buffer_load_dwordx4 v15, s[44:47], s65 offen offset:0 lds
    s_add_u32 s65, s64, 6144
    buffer_load_dwordx4 v15, s[44:47], s65 offen offset:1024 lds
    s_add_u32 s65, s64, 12288
    buffer_load_dwordx4 v15, s[44:47], s65 offen offset:2048 lds
    s_add_u32 s65, s64, 18432
    buffer_load_dwordx4 v15, s[44:47], s65 offen offset:3072 lds
    s_add_u32 m0, s63, 4096
    s_add_u32 s65, s64, 28672
    buffer_load_dwordx4 v15, s[44:47], s65 offen offset:0 lds
    s_add_u32 s65, s64, 34816
    buffer_load_dwordx4 v15, s[44:47], s65 offen offset:1024 lds
    s_add_u32 s65, s64, 40960
    buffer_load_dwordx4 v15, s[44:47], s65 offen offset:2048 lds
    s_add_u32 s65, s64, 47104
    buffer_load_dwordx4 v15, s[44:47], s65 offen offset:3072 lds
    s_waitcnt vmcnt(8)
    s_mov_b64 exec, 1
    buffer_atomic_add v13, v1, s[32:35], s31 offen sc1
    s_mov_b64 exec, -1
    s_cmp_lt_u32 s54, 28
    s_cbranch_scc0 L_fin
    s_mov_b32 s82, 1048576
L_lw_c7:
    ds_read_b32 v243, v241 offset:352
    s_sub_u32 s82, s82, 1
    s_waitcnt lgkmcnt(0)
    v_cmp_ne_u32 vcc, 1, v243
    s_cmp_eq_u32 s82, 0
    s_cbranch_scc1 L_lwx_c7
    s_cbranch_vccnz L_lws_c7
L_lwx_c7:
    s_mul_i32 s63, s80, 6144
    s_mul_i32 s64, s80, 43008
    s_lshl_b32 s65, s83, 7
    s_add_u32 s64, s64, s65
    s_add_u32 m0, s63, 32768
    s_add_u32 s65, s64, 229376
    buffer_load_dwordx4 v15, s[44:47], s65 offen offset:0 lds
    s_add_u32 s65, s64, 235520
    buffer_load_dwordx4 v15, s[44:47], s65 offen offset:1024 lds
    s_add_u32 s65, s64, 241664
    buffer_load_dwordx4 v15, s[44:47], s65 offen offset:2048 lds
    s_add_u32 s65, s64, 247808
    buffer_load_dwordx4 v15, s[44:47], s65 offen offset:3072 lds
    s_add_u32 m0, s63, 36864
    s_add_u32 s65, s64, 258048
    buffer_load_dwordx4 v15, s[44:47], s65 offen offset:0 lds
    s_add_u32 s65, s64, 264192
    buffer_load_dwordx4 v15, s[44:47], s65 offen offset:1024 lds
    s_mov_b64 exec, 1
    s_mov_b32 s82, 65536
L_poll_s3b:
    v_mov_b32 v240, 0
    s_sub_u32 s82, s82, 1
    buffer_atomic_add v240, v1, s[32:35], s24 offen sc0 sc1
    s_cmp_eq_u32 s82, 0
    s_waitcnt vmcnt(0)
    ds_write_b32 v242, v13 offset:192
    v_cmp_ne_u32 vcc, 16, v240
    s_cbranch_scc1 L_pollx_s3b
    s_cbranch_vccnz L_poll_s3b
L_pollx_s3b:
    s_mov_b64 exec, -1
    buffer_load_dwordx4 v[48:51], v2, s[32:35], s25 offen offset:0 sc1
    buffer_load_dwordx4 v[52:55], v2, s[32:35], s25 offen offset:2048 sc1
    s_add_u32 s25, s25, 4096
    buffer_load_dwordx4 v[56:59], v2, s[32:35], s25 offen offset:0 sc1
    buffer_load_dwordx4 v[60:63], v2, s[32:35], s25 offen offset:2048 sc1
    s_add_u32 s25, s25, 4096
    buffer_load_dwordx4 v[64:67], v2, s[32:35], s25 offen offset:0 sc1
    buffer_load_dwordx4 v[68:71], v2, s[32:35], s25 offen offset:2048 sc1
    s_add_u32 s25, s25, 4096
    buffer_load_dwordx4 v[72:75], v2, s[32:35], s25 offen offset:0 sc1
    buffer_load_dwordx4 v[76:79], v2, s[32:35], s25 offen offset:2048 sc1
    buffer_load_dwordx4 v[80:83], v2, s[32:35], s26 offen offset:0 sc1
    buffer_load_dwordx4 v[84:87], v2, s[32:35], s26 offen offset:2048 sc1
    s_add_u32 s26, s26, 4096
    buffer_load_dwordx4 v[88:91], v2, s[32:35], s26 offen offset:0 sc1
    buffer_load_dwordx4 v[92:95], v2, s[32:35], s26 offen offset:2048 sc1
    s_add_u32 s26, s26, 4096
    buffer_load_dwordx4 v[96:99], v2, s[32:35], s26 offen offset:0 sc1
    buffer_load_dwordx4 v[100:103], v2, s[32:35], s26 offen offset:2048 sc1
    s_add_u32 s26, s26, 4096
    buffer_load_dwordx4 v[104:107], v2, s[32:35], s26 offen offset:0 sc1
    buffer_load_dwordx4 v[108:111], v2, s[32:35], s26 offen offset:2048 sc1
    s_mov_b32 s82, 1048576
L_lw_r8s:
    ds_read_b32 v243, v241 offset:192
    s_sub_u32 s82, s82, 1
    s_waitcnt lgkmcnt(0)
    v_cmp_ne_u32 vcc, 1, v243
    s_cmp_eq_u32 s82, 0
    s_cbranch_scc1 L_lwx_r8s
    s_cbranch_vccnz L_lws_r8s
L_lwx_r8s:
    s_setprio 0
    ds_read_b64_tr_b16 v[112:113], v32 offset:0
    ds_read_b64_tr_b16 v[114:115], v36 offset:1024
    ds_read_b64_tr_b16 v[116:117], v33 offset:0
    ds_read_b64_tr_b16 v[118:119], v37 offset:1024
    ds_read_b64_tr_b16 v[120:121], v34 offset:0
    ds_read_b64_tr_b16 v[122:123], v38 offset:1024
    ds_read_b64_tr_b16 v[124:125], v35 offset:0
    ds_read_b64_tr_b16 v[126:127], v39 offset:1024
    ds_read_b64_tr_b16 v[128:129], v34 offset:3584
    ds_read_b64_tr_b16 v[130:131], v38 offset:4608
    ds_read_b64_tr_b16 v[132:133], v35 offset:3584
    ds_read_b64_tr_b16 v[134:135], v39 offset:4608
    ds_read_b64_tr_b16 v[136:137], v32 offset:3584
    ds_read_b64_tr_b16 v[138:139], v36 offset:4608
    ds_read_b64_tr_b16 v[140:141], v33 offset:3584
    ds_read_b64_tr_b16 v[142:143], v37 offset:4608
    s_waitcnt lgkmcnt(0)
    ds_read_b64_tr_b16 v[144:145], v32 offset:14336
    ds_read_b64_tr_b16 v[146:147], v36 offset:15360
    ds_read_b64_tr_b16 v[148:149], v33 offset:14336
    ds_read_b64_tr_b16 v[150:151], v37 offset:15360
    ds_read_b64_tr_b16 v[152:153], v34 offset:14336
    ds_read_b64_tr_b16 v[154:155], v38 offset:15360
    ds_read_b64_tr_b16 v[156:157], v35 offset:14336
    ds_read_b64_tr_b16 v[158:159], v39 offset:15360
    ds_read_b64_tr_b16 v[160:161], v34 offset:17920
    ds_read_b64_tr_b16 v[162:163], v38 offset:18944
    ds_read_b64_tr_b16 v[164:165], v35 offset:17920
    ds_read_b64_tr_b16 v[166:167], v39 offset:18944
    ds_read_b64_tr_b16 v[168:169], v32 offset:17920
    ds_read_b64_tr_b16 v[170:171], v36 offset:18944
    ds_read_b64_tr_b16 v[172:173], v33 offset:17920
    ds_read_b64_tr_b16 v[174:175], v37 offset:18944
    s_waitcnt lgkmcnt(0)
    ds_read_b64_tr_b16 v[176:177], v32 offset:28672
    ds_read_b64_tr_b16 v[178:179], v36 offset:29696
    ds_read_b64_tr_b16 v[180:181], v33 offset:28672
    ds_read_b64_tr_b16 v[182:183], v37 offset:29696
    ds_read_b64_tr_b16 v[184:185], v34 offset:28672
    ds_read_b64_tr_b16 v[186:187], v38 offset:29696
    ds_read_b64_tr_b16 v[188:189], v35 offset:28672
    ds_read_b64_tr_b16 v[190:191], v39 offset:29696
    ds_read_b64_tr_b16 v[192:193], v34 offset:32256
    ds_read_b64_tr_b16 v[194:195], v38 offset:33280
    ds_read_b64_tr_b16 v[196:197], v35 offset:32256
    ds_read_b64_tr_b16 v[198:199], v39 offset:33280
    ds_read_b64_tr_b16 v[200:201], v32 offset:32256
    ds_read_b64_tr_b16 v[202:203], v36 offset:33280
    ds_read_b64_tr_b16 v[204:205], v33 offset:32256
    ds_read_b64_tr_b16 v[206:207], v37 offset:33280
    s_waitcnt lgkmcnt(0)
    ds_read_b64_tr_b16 v[208:209], v32 offset:43008
    ds_read_b64_tr_b16 v[210:211], v36 offset:44032
    ds_read_b64_tr_b16 v[212:213], v33 offset:43008
    ds_read_b64_tr_b16 v[214:215], v37 offset:44032
    ds_read_b64_tr_b16 v[216:217], v34 offset:43008
    ds_read_b64_tr_b16 v[218:219], v38 offset:44032
    ds_read_b64_tr_b16 v[220:221], v35 offset:43008
    ds_read_b64_tr_b16 v[222:223], v39 offset:44032
    ds_read_b64_tr_b16 v[224:225], v34 offset:46592
    ds_read_b64_tr_b16 v[226:227], v38 offset:47616
    ds_read_b64_tr_b16 v[228:229], v35 offset:46592
    ds_read_b64_tr_b16 v[230:231], v39 offset:47616
    ds_read_b64_tr_b16 v[232:233], v32 offset:46592
    ds_read_b64_tr_b16 v[234:235], v36 offset:47616
    ds_read_b64_tr_b16 v[236:237], v33 offset:46592
    ds_read_b64_tr_b16 v[238:239], v37 offset:47616
    s_waitcnt lgkmcnt(0)
    s_mov_b32 s82, 1048576
L_lw_w8:
    ds_read_b32 v243, v242 offset:64
    s_sub_u32 s82, s82, 1
    s_waitcnt lgkmcnt(0)
    v_cmp_ne_u32 vcc, 1, v243
    s_cmp_eq_u32 s82, 0
    s_cbranch_scc1 L_lwx_w8
    s_cbranch_vccnz L_lws_w8
L_lwx_w8:
    s_branch L_p3
L_poll_s1b:
    buffer_load_dword v240, v12, s[32:35], s72 offen sc1
    s_sub_u32 s82, s82, 1
    s_cmp_eq_u32 s82, 0
    s_waitcnt vmcnt(0)
    v_cmp_ne_u32 vcc, 1, v240
    s_cbranch_scc1 L_pollx_s1b
    s_cbranch_vccnz L_poll_s1b
    s_branch L_pollx_s1b
L_poll_fb:
    buffer_load_dword v240, v12, s[32:35], s60 offen sc1
    s_sub_u32 s82, s82, 1
    s_cmp_eq_u32 s82, 0
    s_waitcnt vmcnt(0)
    v_cmp_ne_u32 vcc, 1, v240
    s_cbranch_scc1 L_pollx_fb
    s_cbranch_vccnz L_poll_fb
    s_branch L_pollx_fb
L_poll_fk:
    buffer_load_dword v240, v12, s[32:35], s60 offen sc1
    s_sub_u32 s82, s82, 1
    s_cmp_eq_u32 s82, 0
    s_waitcnt vmcnt(0)
    v_cmp_ne_u32 vcc, 1, v240
    s_cbranch_scc1 L_pollx_fk
    s_cbranch_vccnz L_poll_fk
    s_branch L_pollx_fk
L_lws_c1:
    s_sleep 6
    s_branch L_lw_c1
L_lws_r2:
    s_sleep 6
    s_branch L_lw_r2
L_lws_c2:
    s_sleep 6
    s_branch L_lw_c2
L_lws_c3:
    s_sleep 6
    s_branch L_lw_c3
L_lws_c4:
    s_sleep 6
    s_branch L_lw_c4
L_lws_c5:
    s_sleep 6
    s_branch L_lw_c5
L_lws_c6:
    s_sleep 6
    s_branch L_lw_c6
L_lws_c7:
    s_sleep 6
    s_branch L_lw_c7
L_lws_r8s:
    s_sleep 6
    s_branch L_lw_r8s
L_lws_w8:
    s_sleep 6
    s_branch L_lw_w8
.p2align 12
L_p1_B:
    v_bfe_u32 v4, v1, 2, 2
    v_lshl_add_u32 v4, v3, 3, v4
    v_mul_u32_u24 v200, 56, v4
    v_bfe_u32 v4, v1, 4, 1
    v_and_b32 v5, 3, v1
    v_lshl_add_u32 v4, v4, 2, v5
    v_min_u32 v4, 6, v4
    v_lshl_add_u32 v200, v4, 3, v200
    s_mul_i32 s60, s3, 1568
    s_add_u32 s60, s60, 155648
    v_add_u32 v200, s60, v200
    s_lshl_b32 s60, s52, 12
    s_add_u32 s60, s60, 139264
    v_add_u32 v201, s60, v206
    v_and_b32 v4, 31, v1
    v_bfe_u32 v5, v1, 1, 2
    v_lshlrev_b32 v6, 1, v3
    v_xor_b32 v5, v5, v6
    v_lshlrev_b32 v5, 4, v5
    v_lshl_add_u32 v4, v4, 6, v5
    s_lshl_b32 s60, s3, 14
    s_lshl_b32 s61, s93, 12
    s_add_u32 s60, s60, s61
    s_add_u32 s60, s60, 106496
    v_add_u32 v202, s60, v4
    v_xor_b32 v203, 16, v202
    s_lshl_b32 s60, s68, 6
    s_add_u32 s60, s60, s64
    s_lshl_b32 s60, s60, 11
    s_add_u32 s24, s60, 6291456
    v_lshlrev_b32 v207, 31, v3
    v_ashrrev_i32 v207, 8, v207
    v_bfe_u32 v4, v1, 2, 2
    v_lshl_add_u32 v5, v3, 3, v4
    v_lshrrev_b32 v6, 1, v4
    v_bfe_u32 v7, v1, 4, 1
    v_and_b32 v4, 2, v1
    v_or_b32 v7, v7, v4
    v_xor_b32 v6, v6, v7
    v_lshlrev_b32 v6, 4, v6
    v_lshl_add_u32 v5, v5, 6, v6
    v_and_b32 v4, 1, v1
    v_lshl_add_u32 v5, v4, 3, v5
    s_lshl_b32 s60, s80, 13
    s_add_u32 s60, s60, 106496
    v_add_u32 v204, s60, v5
    v_add_u32 v247, s60, v2
    v_xor_b32 v205, 32, v204
    s_lshr_b32 s62, s80, 1
    s_lshl_b32 s60, s62, 13
    s_add_u32 s60, s60, 139264
    v_add_u32 v246, s60, v2
    s_lshl_b32 s60, s57, 1
    s_add_u32 s60, s60, s62
    s_lshl_b32 s60, s60, 4
    s_add_u32 s60, s60, s56
    s_lshl_b32 s60, s60, 1
    s_and_b32 s61, s80, 1
    s_add_u32 s60, s60, s61
    s_lshl_b32 s60, s60, 12
    s_add_u32 s68, s60, 8388608
    s_waitcnt lgkmcnt(0)
    s_barrier
    ds_read_b64_tr_b16 v[40:41], v18 offset:0
    ds_read_b64_tr_b16 v[42:43], v18 offset:3072
    ds_read_b128 v[24:27], v16 offset:0
    ds_read_b128 v[28:31], v16 offset:2048
    ds_read_b128 v[32:35], v16 offset:4096
    ds_read_b128 v[36:39], v16 offset:6144
    ds_read_b64_tr_b16 v[44:45], v19 offset:0
    ds_read_b64_tr_b16 v[46:47], v19 offset:3072
    ds_read_b64_tr_b16 v[48:49], v20 offset:0
    ds_read_b64_tr_b16 v[50:51], v20 offset:3072
    ds_read_b64_tr_b16 v[52:53], v21 offset:0
    ds_read_b64_tr_b16 v[54:55], v21 offset:3072
    ds_read_b64_tr_b16 v[56:57], v22 offset:0
    ds_read_b64_tr_b16 v[58:59], v22 offset:3072
    ds_read_b64_tr_b16 v[60:61], v23 offset:0
    ds_read_b64_tr_b16 v[62:63], v23 offset:3072
    s_or_b32 s61, s100, s52
    s_cbranch_scc0 L_sig0
.p2align 3
L_p1l_B:
    s_waitcnt lgkmcnt(0)
    s_add_u32 s70, s70, 1
    v_mfma_f32_16x16x32_bf16 v[64:67], v[40:43], v[24:27], v[64:67]
    ds_read_b64_tr_b16 v[176:177], v18 offset:12288
    v_mfma_f32_16x16x32_bf16 v[72:75], v[40:43], v[28:31], v[72:75]
    ds_read_b64_tr_b16 v[178:179], v18 offset:15360
    v_mfma_f32_16x16x32_bf16 v[80:83], v[40:43], v[32:35], v[80:83]
    ds_read_b128 v[160:163], v17 offset:0
    v_mfma_f32_16x16x32_bf16 v[88:91], v[40:43], v[36:39], v[88:91]
    ds_read_b128 v[164:167], v17 offset:2048
    v_mfma_f32_16x16x32_bf16 v[68:71], v[44:47], v[24:27], v[68:71]
    ds_read_b128 v[168:171], v17 offset:4096
    v_mfma_f32_16x16x32_bf16 v[76:79], v[44:47], v[28:31], v[76:79]
    ds_read_b128 v[172:175], v17 offset:6144
    v_mfma_f32_16x16x32_bf16 v[84:87], v[44:47], v[32:35], v[84:87]
    ds_read_b64_tr_b16 v[180:181], v19 offset:12288
    v_mfma_f32_16x16x32_bf16 v[92:95], v[44:47], v[36:39], v[92:95]
    ds_read_b64_tr_b16 v[182:183], v19 offset:15360
    v_mfma_f32_16x16x32_bf16 v[96:99], v[48:51], v[24:27], v[96:99]
    ds_read_b64_tr_b16 v[184:185], v20 offset:12288
    v_mfma_f32_16x16x32_bf16 v[104:107], v[48:51], v[28:31], v[104:107]
    ds_read_b64_tr_b16 v[186:187], v20 offset:15360
    v_mfma_f32_16x16x32_bf16 v[112:115], v[48:51], v[32:35], v[112:115]
    ds_read_b64_tr_b16 v[188:189], v21 offset:12288
    v_mfma_f32_16x16x32_bf16 v[120:123], v[48:51], v[36:39], v[120:123]
    ds_read_b64_tr_b16 v[190:191], v21 offset:15360
    v_mfma_f32_16x16x32_bf16 v[100:103], v[52:55], v[24:27], v[100:103]
    ds_read_b64_tr_b16 v[192:193], v22 offset:12288
    v_mfma_f32_16x16x32_bf16 v[108:111], v[52:55], v[28:31], v[108:111]
    ds_read_b64_tr_b16 v[194:195], v22 offset:15360
    v_mfma_f32_16x16x32_bf16 v[116:119], v[52:55], v[32:35], v[116:119]
    ds_read_b64_tr_b16 v[196:197], v23 offset:12288
    v_mfma_f32_16x16x32_bf16 v[124:127], v[52:55], v[36:39], v[124:127]
    ds_read_b64_tr_b16 v[198:199], v23 offset:15360
    v_mfma_f32_16x16x32_bf16 v[128:131], v[24:27], v[56:59], v[128:131]
    v_add_u32 v16, s65, v16
    v_add_u32 v17, s65, v17
    v_mfma_f32_16x16x32_bf16 v[132:135], v[28:31], v[56:59], v[132:135]
    v_add_u32 v18, s65, v18
    v_add_u32 v19, s65, v19
    v_mfma_f32_16x16x32_bf16 v[144:147], v[32:35], v[56:59], v[144:147]
    v_add_u32 v20, s65, v20
    v_add_u32 v21, s65, v21
    v_mfma_f32_16x16x32_bf16 v[148:151], v[36:39], v[56:59], v[148:151]
    v_add_u32 v22, s65, v22
    v_add_u32 v23, s65, v23
    v_mfma_f32_16x16x32_bf16 v[136:139], v[24:27], v[60:63], v[136:139]
    v_mfma_f32_16x16x32_bf16 v[140:143], v[28:31], v[60:63], v[140:143]
    v_mfma_f32_16x16x32_bf16 v[152:155], v[32:35], v[60:63], v[152:155]
    v_mfma_f32_16x16x32_bf16 v[156:159], v[36:39], v[60:63], v[156:159]
    s_waitcnt lgkmcnt(0)
    s_nop 0
    v_mfma_f32_16x16x32_bf16 v[64:67], v[176:179], v[160:163], v[64:67]
    s_add_u32 s71, s71, 1
    s_cmp_eq_u32 s71, 2
    v_mfma_f32_16x16x32_bf16 v[72:75], v[176:179], v[164:167], v[72:75]
    s_cselect_b32 s71, -1, s71
    s_cselect_b32 s65, s67, s66
    v_mfma_f32_16x16x32_bf16 v[80:83], v[176:179], v[168:171], v[80:83]
    v_mfma_f32_16x16x32_bf16 v[88:91], v[176:179], v[172:175], v[88:91]
    v_mfma_f32_16x16x32_bf16 v[68:71], v[180:183], v[160:163], v[68:71]
    v_mfma_f32_16x16x32_bf16 v[76:79], v[180:183], v[164:167], v[76:79]
    v_mfma_f32_16x16x32_bf16 v[84:87], v[180:183], v[168:171], v[84:87]
    v_mfma_f32_16x16x32_bf16 v[92:95], v[180:183], v[172:175], v[92:95]
    v_mfma_f32_16x16x32_bf16 v[96:99], v[184:187], v[160:163], v[96:99]
    v_mfma_f32_16x16x32_bf16 v[104:107], v[184:187], v[164:167], v[104:107]
    v_mfma_f32_16x16x32_bf16 v[112:115], v[184:187], v[168:171], v[112:115]
    v_mfma_f32_16x16x32_bf16 v[120:123], v[184:187], v[172:175], v[120:123]
    s_barrier
    s_nop 0
    ds_read_b64_tr_b16 v[40:41], v18 offset:0
    ds_read_b64_tr_b16 v[42:43], v18 offset:3072
    v_mfma_f32_16x16x32_bf16 v[100:103], v[188:191], v[160:163], v[100:103]
    ds_read_b128 v[24:27], v16 offset:0
    ds_read_b128 v[28:31], v16 offset:2048
    v_mfma_f32_16x16x32_bf16 v[108:111], v[188:191], v[164:167], v[108:111]
    ds_read_b128 v[32:35], v16 offset:4096
    ds_read_b128 v[36:39], v16 offset:6144
    v_mfma_f32_16x16x32_bf16 v[116:119], v[188:191], v[168:171], v[116:119]
    ds_read_b64_tr_b16 v[44:45], v19 offset:0
    ds_read_b64_tr_b16 v[46:47], v19 offset:3072
    v_mfma_f32_16x16x32_bf16 v[124:127], v[188:191], v[172:175], v[124:127]
    ds_read_b64_tr_b16 v[48:49], v20 offset:0
    ds_read_b64_tr_b16 v[50:51], v20 offset:3072
    v_mfma_f32_16x16x32_bf16 v[128:131], v[160:163], v[192:195], v[128:131]
    ds_read_b64_tr_b16 v[52:53], v21 offset:0
    ds_read_b64_tr_b16 v[54:55], v21 offset:3072
    v_mfma_f32_16x16x32_bf16 v[132:135], v[164:167], v[192:195], v[132:135]
    ds_read_b64_tr_b16 v[56:57], v22 offset:0
    ds_read_b64_tr_b16 v[58:59], v22 offset:3072
    v_mfma_f32_16x16x32_bf16 v[144:147], v[168:171], v[192:195], v[144:147]
    ds_read_b64_tr_b16 v[60:61], v23 offset:0
    ds_read_b64_tr_b16 v[62:63], v23 offset:3072
    v_mfma_f32_16x16x32_bf16 v[148:151], v[172:175], v[192:195], v[148:151]
    v_mfma_f32_16x16x32_bf16 v[136:139], v[160:163], v[196:199], v[136:139]
    v_mfma_f32_16x16x32_bf16 v[140:143], v[164:167], v[196:199], v[140:143]
    v_mfma_f32_16x16x32_bf16 v[152:155], v[168:171], v[196:199], v[152:155]
    v_mfma_f32_16x16x32_bf16 v[156:159], v[172:175], v[196:199], v[156:159]
    s_cmp_lt_u32 s70, 6
    s_cbranch_scc1 L_p1l_B
    s_waitcnt lgkmcnt(0)
    s_nop 0
    v_mfma_f32_16x16x32_bf16 v[96:99], v[48:51], v[24:27], v[96:99]
    ds_read_b64_tr_b16 v[176:177], v18 offset:12288
    ds_read_b64_tr_b16 v[178:179], v18 offset:15360
    v_mfma_f32_16x16x32_bf16 v[104:107], v[48:51], v[28:31], v[104:107]
    ds_read_b128 v[160:163], v17 offset:0
    ds_read_b128 v[164:167], v17 offset:2048
    v_mfma_f32_16x16x32_bf16 v[112:115], v[48:51], v[32:35], v[112:115]
    ds_read_b128 v[168:171], v17 offset:4096
    ds_read_b128 v[172:175], v17 offset:6144
    v_mfma_f32_16x16x32_bf16 v[120:123], v[48:51], v[36:39], v[120:123]
    ds_read_b64_tr_b16 v[180:181], v19 offset:12288
    ds_read_b64_tr_b16 v[182:183], v19 offset:15360
    v_mfma_f32_16x16x32_bf16 v[100:103], v[52:55], v[24:27], v[100:103]
    ds_read_b64_tr_b16 v[184:185], v20 offset:12288
    ds_read_b64_tr_b16 v[186:187], v20 offset:15360
    v_mfma_f32_16x16x32_bf16 v[108:111], v[52:55], v[28:31], v[108:111]
    ds_read_b64_tr_b16 v[188:189], v21 offset:12288
    ds_read_b64_tr_b16 v[190:191], v21 offset:15360
    v_mfma_f32_16x16x32_bf16 v[116:119], v[52:55], v[32:35], v[116:119]
    ds_read_b64_tr_b16 v[192:193], v22 offset:12288
    ds_read_b64_tr_b16 v[194:195], v22 offset:15360
    v_mfma_f32_16x16x32_bf16 v[124:127], v[52:55], v[36:39], v[124:127]
    ds_read_b64_tr_b16 v[196:197], v23 offset:12288
    ds_read_b64_tr_b16 v[198:199], v23 offset:15360
    v_mfma_f32_16x16x32_bf16 v[128:131], v[24:27], v[56:59], v[128:131]
    v_mfma_f32_16x16x32_bf16 v[132:135], v[28:31], v[56:59], v[132:135]
    v_mfma_f32_16x16x32_bf16 v[144:147], v[32:35], v[56:59], v[144:147]
    v_mfma_f32_16x16x32_bf16 v[148:151], v[36:39], v[56:59], v[148:151]
    v_mfma_f32_16x16x32_bf16 v[136:139], v[24:27], v[60:63], v[136:139]
    v_mfma_f32_16x16x32_bf16 v[140:143], v[28:31], v[60:63], v[140:143]
    v_mfma_f32_16x16x32_bf16 v[152:155], v[32:35], v[60:63], v[152:155]
    v_mfma_f32_16x16x32_bf16 v[156:159], v[36:39], v[60:63], v[156:159]
    s_waitcnt vmcnt(0) lgkmcnt(0)
    s_barrier
    v_mfma_f32_16x16x32_bf16 v[96:99], v[184:187], v[160:163], v[96:99]
    ds_read_b64_tr_b16 v[208:209], v200 offset:0
    v_mfma_f32_16x16x32_bf16 v[104:107], v[184:187], v[164:167], v[104:107]
    ds_read_b64_tr_b16 v[210:211], v200 offset:896
    v_mfma_f32_16x16x32_bf16 v[112:115], v[184:187], v[168:171], v[112:115]
    ds_read_b64_tr_b16 v[212:213], v200 offset:224
    v_mfma_f32_16x16x32_bf16 v[120:123], v[184:187], v[172:175], v[120:123]
    ds_read_b64_tr_b16 v[214:215], v200 offset:1120
    v_mfma_f32_16x16x32_bf16 v[100:103], v[188:191], v[160:163], v[100:103]
    v_mfma_f32_16x16x32_bf16 v[108:111], v[188:191], v[164:167], v[108:111]
    v_mfma_f32_16x16x32_bf16 v[116:119], v[188:191], v[168:171], v[116:119]
    v_mfma_f32_16x16x32_bf16 v[124:127], v[188:191], v[172:175], v[124:127]
    v_mfma_f32_16x16x32_bf16 v[128:131], v[160:163], v[192:195], v[128:131]
    v_mfma_f32_16x16x32_bf16 v[132:135], v[164:167], v[192:195], v[132:135]
    v_mfma_f32_16x16x32_bf16 v[144:147], v[168:171], v[192:195], v[144:147]
    v_mfma_f32_16x16x32_bf16 v[148:151], v[172:175], v[192:195], v[148:151]
    v_cvt_pk_bf16_f32 v216, v96, v97
    v_cvt_pk_bf16_f32 v217, v98, v99
    v_mfma_f32_16x16x32_bf16 v[136:139], v[160:163], v[196:199], v[136:139]
    v_cvt_pk_bf16_f32 v218, v100, v101
    v_cvt_pk_bf16_f32 v219, v102, v103
    v_mfma_f32_16x16x32_bf16 v[140:143], v[164:167], v[196:199], v[140:143]
    v_cvt_pk_bf16_f32 v220, v104, v105
    v_cvt_pk_bf16_f32 v221, v106, v107
    v_mfma_f32_16x16x32_bf16 v[152:155], v[168:171], v[196:199], v[152:155]
    v_cvt_pk_bf16_f32 v222, v108, v109
    v_cvt_pk_bf16_f32 v223, v110, v111
    v_mfma_f32_16x16x32_bf16 v[156:159], v[172:175], v[196:199], v[156:159]
    v_cvt_pk_bf16_f32 v224, v112, v113
    v_cvt_pk_bf16_f32 v225, v114, v115
    v_mfma_f32_16x16x32_bf16 v[64:67], v[40:43], v[24:27], v[64:67]
    v_cvt_pk_bf16_f32 v226, v116, v117
    v_cvt_pk_bf16_f32 v227, v118, v119
    v_mfma_f32_16x16x32_bf16 v[72:75], v[40:43], v[28:31], v[72:75]
    v_cvt_pk_bf16_f32 v228, v120, v121
    v_cvt_pk_bf16_f32 v229, v122, v123
    v_mfma_f32_16x16x32_bf16 v[80:83], v[40:43], v[32:35], v[80:83]
    v_cvt_pk_bf16_f32 v230, v124, v125
    v_cvt_pk_bf16_f32 v231, v126, v127
    v_mfma_f32_16x16x32_bf16 v[88:91], v[40:43], v[36:39], v[88:91]
    v_permlane16_swap_b32 v216, v220
    v_permlane16_swap_b32 v217, v221
    v_mfma_f32_16x16x32_bf16 v[68:71], v[44:47], v[24:27], v[68:71]
    v_permlane16_swap_b32 v218, v222
    v_permlane16_swap_b32 v219, v223
    v_mfma_f32_16x16x32_bf16 v[76:79], v[44:47], v[28:31], v[76:79]
    v_permlane16_swap_b32 v224, v228
    v_permlane16_swap_b32 v225, v229
    v_mfma_f32_16x16x32_bf16 v[84:87], v[44:47], v[32:35], v[84:87]
    v_permlane16_swap_b32 v226, v230
    v_permlane16_swap_b32 v227, v231
    v_mfma_f32_16x16x32_bf16 v[92:95], v[44:47], v[36:39], v[92:95]
    v_cvt_pk_bf16_f32 v128, v128, v129
    v_cvt_pk_bf16_f32 v129, v130, v131
    v_mfma_f32_16x16x32_bf16 v[64:67], v[176:179], v[160:163], v[64:67]
    v_cvt_pk_bf16_f32 v130, v132, v133
    v_cvt_pk_bf16_f32 v131, v134, v135
    v_mfma_f32_16x16x32_bf16 v[72:75], v[176:179], v[164:167], v[72:75]
    v_cvt_pk_bf16_f32 v132, v136, v137
    v_cvt_pk_bf16_f32 v133, v138, v139
    v_mfma_f32_16x16x32_bf16 v[80:83], v[176:179], v[168:171], v[80:83]
    v_cvt_pk_bf16_f32 v134, v140, v141
    v_cvt_pk_bf16_f32 v135, v142, v143
    v_mfma_f32_16x16x32_bf16 v[88:91], v[176:179], v[172:175], v[88:91]
    v_cvt_pk_bf16_f32 v136, v144, v145
    v_cvt_pk_bf16_f32 v137, v146, v147
    v_mfma_f32_16x16x32_bf16 v[68:71], v[180:183], v[160:163], v[68:71]
    v_cvt_pk_bf16_f32 v138, v148, v149
    v_cvt_pk_bf16_f32 v139, v150, v151
    v_mfma_f32_16x16x32_bf16 v[76:79], v[180:183], v[164:167], v[76:79]
    v_cvt_pk_bf16_f32 v140, v152, v153
    v_cvt_pk_bf16_f32 v141, v154, v155
    v_mfma_f32_16x16x32_bf16 v[84:87], v[180:183], v[168:171], v[84:87]
    v_cvt_pk_bf16_f32 v142, v156, v157
    v_cvt_pk_bf16_f32 v143, v158, v159
    v_mfma_f32_16x16x32_bf16 v[92:95], v[180:183], v[172:175], v[92:95]
    s_waitcnt lgkmcnt(0)
    s_nop 0
    v_mfma_f32_32x32x16_bf16 v[168:183], v[208:211], v[216:219], 0
    ds_write_b128 v201, v[128:131] offset:0
    ds_write_b128 v201, v[132:135] offset:256
    ds_write_b128 v201, v[136:139] offset:2048
    ds_write_b128 v201, v[140:143] offset:2304
    v_mfma_f32_32x32x16_bf16 v[168:183], v[212:215], v[220:223], v[168:183]
    v_cvt_pk_bf16_f32 v32, v64, v65
    v_cvt_pk_bf16_f32 v33, v66, v67
    v_cvt_pk_bf16_f32 v34, v68, v69
    v_cvt_pk_bf16_f32 v35, v70, v71
    v_mfma_f32_32x32x16_bf16 v[184:199], v[208:211], v[224:227], 0
    v_cvt_pk_bf16_f32 v36, v72, v73
    v_cvt_pk_bf16_f32 v37, v74, v75
    v_cvt_pk_bf16_f32 v38, v76, v77
    v_cvt_pk_bf16_f32 v39, v78, v79
    v_mfma_f32_32x32x16_bf16 v[184:199], v[212:215], v[228:231], v[184:199]
    v_cvt_pk_bf16_f32 v40, v80, v81
    v_cvt_pk_bf16_f32 v41, v82, v83
    v_cvt_pk_bf16_f32 v42, v84, v85
    v_cvt_pk_bf16_f32 v43, v86, v87
    v_cvt_pk_bf16_f32 v44, v88, v89
    v_cvt_pk_bf16_f32 v45, v90, v91
    v_cvt_pk_bf16_f32 v46, v92, v93
    v_cvt_pk_bf16_f32 v47, v94, v95
    v_max3_f32 v4, v168, v169, v170
    v_max3_f32 v6, -v168, -v169, -v170
    s_nop 1
    v_max3_f32 v8, v184, v185, v186
    v_max3_f32 v10, -v184, -v185, -v186
    v_max3_f32 v4, v4, v171, v172
    v_max3_f32 v6, v6, -v171, -v172
    v_max3_f32 v8, v8, v187, v188
    v_max3_f32 v10, v10, -v187, -v188
    v_max3_f32 v4, v4, v173, v174
    v_max3_f32 v6, v6, -v173, -v174
    v_max3_f32 v8, v8, v189, v190
    v_max3_f32 v10, v10, -v189, -v190
    v_max3_f32 v4, v4, v175, v176
    v_max3_f32 v6, v6, -v175, -v176
    v_max3_f32 v8, v8, v191, v192
    v_max3_f32 v10, v10, -v191, -v192
    v_max3_f32 v4, v4, v177, v178
    v_max3_f32 v6, v6, -v177, -v178
    v_max3_f32 v8, v8, v193, v194
    v_max3_f32 v10, v10, -v193, -v194
    v_max3_f32 v4, v4, v179, v180
    v_max3_f32 v6, v6, -v179, -v180
    v_max3_f32 v8, v8, v195, v196
    v_max3_f32 v10, v10, -v195, -v196
    v_max3_f32 v4, v4, v181, v182
    v_max3_f32 v6, v6, -v181, -v182
    v_max3_f32 v8, v8, v197, v198
    v_max3_f32 v10, v10, -v197, -v198
    v_max_f32_e64 v4, v4, v183
    v_max_f32_e64 v6, v6, -v183
    v_max_f32_e64 v8, v8, v199
    v_max_f32_e64 v10, v10, -v199
    s_nop 0
    v_permlane32_swap_b32 v4, v6
    v_permlane32_swap_b32 v8, v10
    v_max_f32 v4, v4, v6
    v_max_f32 v8, v8, v10
    s_nop 0
    v_mul_f32_e64 v6, -v4, s78
    v_mul_f32_e64 v4, -v4, s78
    v_mul_f32_e64 v10, -v8, s78
    v_mul_f32_e64 v8, -v8, s78
    s_nop 0
    v_permlane32_swap_b32 v4, v6
    v_permlane32_swap_b32 v8, v10
    v_add_f32 v5, v4, v207
    v_add_f32 v7, v6, v207
    v_add_f32 v9, v8, v207
    v_add_f32 v11, v10, v207
    s_nop 0
    v_pk_fma_f32 v[64:65], v[168:169], s[78:79], v[4:5] op_sel_hi:[1,1,0]
    v_pk_fma_f32 v[96:97], v[168:169], s[78:79], v[6:7] op_sel_hi:[1,1,0] neg_lo:[1,0,0] neg_hi:[1,0,0]
    v_pk_fma_f32 v[66:67], v[170:171], s[78:79], v[4:5] op_sel_hi:[1,1,0]
    v_pk_fma_f32 v[98:99], v[170:171], s[78:79], v[6:7] op_sel_hi:[1,1,0] neg_lo:[1,0,0] neg_hi:[1,0,0]
    v_pk_fma_f32 v[68:69], v[172:173], s[78:79], v[4:5] op_sel_hi:[1,1,0]
    v_pk_fma_f32 v[100:101], v[172:173], s[78:79], v[6:7] op_sel_hi:[1,1,0] neg_lo:[1,0,0] neg_hi:[1,0,0]
    v_pk_fma_f32 v[70:71], v[174:175], s[78:79], v[4:5] op_sel_hi:[1,1,0]
    v_pk_fma_f32 v[102:103], v[174:175], s[78:79], v[6:7] op_sel_hi:[1,1,0] neg_lo:[1,0,0] neg_hi:[1,0,0]
    v_pk_fma_f32 v[72:73], v[176:177], s[78:79], v[4:5] op_sel_hi:[1,1,0]
    v_pk_fma_f32 v[104:105], v[176:177], s[78:79], v[6:7] op_sel_hi:[1,1,0] neg_lo:[1,0,0] neg_hi:[1,0,0]
    v_pk_fma_f32 v[74:75], v[178:179], s[78:79], v[4:5] op_sel_hi:[1,1,0]
    v_pk_fma_f32 v[106:107], v[178:179], s[78:79], v[6:7] op_sel_hi:[1,1,0] neg_lo:[1,0,0] neg_hi:[1,0,0]
    v_pk_fma_f32 v[76:77], v[180:181], s[78:79], v[4:5] op_sel:[0,0,1] op_sel_hi:[1,1,1]
    v_pk_fma_f32 v[108:109], v[180:181], s[78:79], v[6:7] op_sel:[0,0,1] op_sel_hi:[1,1,1] neg_lo:[1,0,0] neg_hi:[1,0,0]
    v_pk_fma_f32 v[78:79], v[182:183], s[78:79], v[4:5] op_sel:[0,0,1] op_sel_hi:[1,1,1]
    v_pk_fma_f32 v[110:111], v[182:183], s[78:79], v[6:7] op_sel:[0,0,1] op_sel_hi:[1,1,1] neg_lo:[1,0,0] neg_hi:[1,0,0]
    v_pk_fma_f32 v[80:81], v[184:185], s[78:79], v[8:9] op_sel_hi:[1,1,0]
    v_pk_fma_f32 v[112:113], v[184:185], s[78:79], v[10:11] op_sel_hi:[1,1,0] neg_lo:[1,0,0] neg_hi:[1,0,0]
    v_pk_fma_f32 v[82:83], v[186:187], s[78:79], v[8:9] op_sel_hi:[1,1,0]
    v_pk_fma_f32 v[114:115], v[186:187], s[78:79], v[10:11] op_sel_hi:[1,1,0] neg_lo:[1,0,0] neg_hi:[1,0,0]
    v_pk_fma_f32 v[84:85], v[188:189], s[78:79], v[8:9] op_sel_hi:[1,1,0]
    v_pk_fma_f32 v[116:117], v[188:189], s[78:79], v[10:11] op_sel_hi:[1,1,0] neg_lo:[1,0,0] neg_hi:[1,0,0]
    v_pk_fma_f32 v[86:87], v[190:191], s[78:79], v[8:9] op_sel_hi:[1,1,0]
    v_pk_fma_f32 v[118:119], v[190:191], s[78:79], v[10:11] op_sel_hi:[1,1,0] neg_lo:[1,0,0] neg_hi:[1,0,0]
    v_pk_fma_f32 v[88:89], v[192:193], s[78:79], v[8:9] op_sel_hi:[1,1,0]
    v_pk_fma_f32 v[120:121], v[192:193], s[78:79], v[10:11] op_sel_hi:[1,1,0] neg_lo:[1,0,0] neg_hi:[1,0,0]
    v_pk_fma_f32 v[90:91], v[194:195], s[78:79], v[8:9] op_sel_hi:[1,1,0]
    v_pk_fma_f32 v[122:123], v[194:195], s[78:79], v[10:11] op_sel_hi:[1,1,0] neg_lo:[1,0,0] neg_hi:[1,0,0]
    v_pk_fma_f32 v[92:93], v[196:197], s[78:79], v[8:9] op_sel:[0,0,1] op_sel_hi:[1,1,1]
    v_pk_fma_f32 v[124:125], v[196:197], s[78:79], v[10:11] op_sel:[0,0,1] op_sel_hi:[1,1,1] neg_lo:[1,0,0] neg_hi:[1,0,0]
    v_pk_fma_f32 v[94:95], v[198:199], s[78:79], v[8:9] op_sel:[0,0,1] op_sel_hi:[1,1,1]
    v_pk_fma_f32 v[126:127], v[198:199], s[78:79], v[10:11] op_sel:[0,0,1] op_sel_hi:[1,1,1] neg_lo:[1,0,0] neg_hi:[1,0,0]
    v_exp_f32 v64, v64
    v_exp_f32 v65, v65
    v_exp_f32 v66, v66
    v_exp_f32 v67, v67
    v_exp_f32 v68, v68
    v_exp_f32 v69, v69
    v_exp_f32 v70, v70
    v_exp_f32 v71, v71
    v_exp_f32 v72, v72
    v_exp_f32 v73, v73
    v_exp_f32 v74, v74
    v_exp_f32 v75, v75
    v_exp_f32 v76, v76
    v_exp_f32 v77, v77
    v_exp_f32 v78, v78
    v_exp_f32 v79, v79
    v_exp_f32 v96, v96
    v_exp_f32 v97, v97
    v_exp_f32 v98, v98
    v_exp_f32 v99, v99
    v_exp_f32 v100, v100
    v_exp_f32 v101, v101
    v_exp_f32 v102, v102
    v_exp_f32 v103, v103
    v_exp_f32 v104, v104
    v_exp_f32 v105, v105
    v_exp_f32 v106, v106
    v_exp_f32 v107, v107
    v_exp_f32 v108, v108
    v_exp_f32 v109, v109
    v_exp_f32 v110, v110
    v_exp_f32 v111, v111
    v_exp_f32 v80, v80
    v_exp_f32 v81, v81
    v_exp_f32 v82, v82
    v_exp_f32 v83, v83
    v_exp_f32 v84, v84
    v_exp_f32 v85, v85
    v_exp_f32 v86, v86
    v_exp_f32 v87, v87
    v_exp_f32 v88, v88
    v_exp_f32 v89, v89
    v_exp_f32 v90, v90
    v_exp_f32 v91, v91
    v_exp_f32 v92, v92
    v_exp_f32 v93, v93
    v_exp_f32 v94, v94
    v_exp_f32 v95, v95
    v_exp_f32 v112, v112
    v_exp_f32 v113, v113
    v_exp_f32 v114, v114
    v_exp_f32 v115, v115
    v_exp_f32 v116, v116
    v_exp_f32 v117, v117
    v_exp_f32 v118, v118
    v_exp_f32 v119, v119
    v_exp_f32 v120, v120
    v_exp_f32 v121, v121
    v_exp_f32 v122, v122
    v_exp_f32 v123, v123
    v_exp_f32 v124, v124
    v_exp_f32 v125, v125
    v_exp_f32 v126, v126
    v_exp_f32 v127, v127
    buffer_store_dwordx4 v[32:35], v206, s[32:35], s24 offen offset:0 sc1
    buffer_store_dwordx4 v[36:39], v206, s[32:35], s24 offen offset:256 sc1
    buffer_store_dwordx4 v[40:43], v206, s[32:35], s24 offen offset:2048 sc1
    buffer_store_dwordx4 v[44:47], v206, s[32:35], s24 offen offset:2304 sc1
    v_pk_add_f32 v[4:5], v[64:65], v[66:67]
    v_pk_add_f32 v[6:7], v[96:97], v[98:99]
    v_pk_add_f32 v[8:9], v[80:81], v[82:83]
    v_pk_add_f32 v[10:11], v[112:113], v[114:115]
    v_pk_add_f32 v[4:5], v[4:5], v[68:69]
    v_pk_add_f32 v[6:7], v[6:7], v[100:101]
    v_pk_add_f32 v[8:9], v[8:9], v[84:85]
    v_pk_add_f32 v[10:11], v[10:11], v[116:117]
    v_pk_add_f32 v[4:5], v[4:5], v[70:71]
    v_pk_add_f32 v[6:7], v[6:7], v[102:103]
    v_pk_add_f32 v[8:9], v[8:9], v[86:87]
    v_pk_add_f32 v[10:11], v[10:11], v[118:119]
    v_pk_add_f32 v[4:5], v[4:5], v[72:73]
    v_pk_add_f32 v[6:7], v[6:7], v[104:105]
    v_pk_add_f32 v[8:9], v[8:9], v[88:89]
    v_pk_add_f32 v[10:11], v[10:11], v[120:121]
    v_pk_add_f32 v[4:5], v[4:5], v[74:75]
    v_pk_add_f32 v[6:7], v[6:7], v[106:107]
    v_pk_add_f32 v[8:9], v[8:9], v[90:91]
    v_pk_add_f32 v[10:11], v[10:11], v[122:123]
    v_pk_add_f32 v[4:5], v[4:5], v[76:77]
    v_pk_add_f32 v[6:7], v[6:7], v[108:109]
    v_pk_add_f32 v[8:9], v[8:9], v[92:93]
    v_pk_add_f32 v[10:11], v[10:11], v[124:125]
    v_pk_add_f32 v[4:5], v[4:5], v[78:79]
    v_pk_add_f32 v[6:7], v[6:7], v[110:111]
    v_pk_add_f32 v[8:9], v[8:9], v[94:95]
    v_pk_add_f32 v[10:11], v[10:11], v[126:127]
    v_add_f32 v4, v4, v5
    v_add_f32 v6, v6, v7
    v_add_f32 v8, v8, v9
    v_add_f32 v10, v10, v11
    s_nop 0
    v_permlane32_swap_b32 v4, v6
    v_permlane32_swap_b32 v8, v10
    v_add_f32 v4, v4, v6
    v_add_f32 v8, v8, v10
    v_rcp_f32 v4, v4
    v_rcp_f32 v8, v8
    v_mov_b32 v6, v4
    v_mov_b32 v10, v8
    s_nop 0
    v_permlane32_swap_b32 v4, v6
    v_permlane32_swap_b32 v8, v10
    v_pk_mul_f32 v[64:65], v[64:65], v[4:5] op_sel_hi:[1,0]
    v_pk_mul_f32 v[66:67], v[66:67], v[4:5] op_sel_hi:[1,0]
    v_pk_mul_f32 v[68:69], v[68:69], v[4:5] op_sel_hi:[1,0]
    v_pk_mul_f32 v[70:71], v[70:71], v[4:5] op_sel_hi:[1,0]
    v_pk_mul_f32 v[72:73], v[72:73], v[4:5] op_sel_hi:[1,0]
    v_pk_mul_f32 v[74:75], v[74:75], v[4:5] op_sel_hi:[1,0]
    v_pk_mul_f32 v[76:77], v[76:77], v[4:5] op_sel_hi:[1,0]
    v_pk_mul_f32 v[78:79], v[78:79], v[4:5] op_sel_hi:[1,0]
    v_cvt_pk_bf16_f32 v168, v64, v65
    v_cvt_pk_bf16_f32 v169, v66, v67
    v_cvt_pk_bf16_f32 v170, v68, v69
    v_cvt_pk_bf16_f32 v171, v70, v71
    v_cvt_pk_bf16_f32 v172, v72, v73
    v_cvt_pk_bf16_f32 v173, v74, v75
    v_cvt_pk_bf16_f32 v174, v76, v77
    v_cvt_pk_bf16_f32 v175, v78, v79
    ds_write_b128 v202, v[168:171] offset:0
    ds_write_b128 v203, v[172:175] offset:0
    v_pk_mul_f32 v[96:97], v[96:97], v[6:7] op_sel_hi:[1,0]
    v_pk_mul_f32 v[98:99], v[98:99], v[6:7] op_sel_hi:[1,0]
    v_pk_mul_f32 v[100:101], v[100:101], v[6:7] op_sel_hi:[1,0]
    v_pk_mul_f32 v[102:103], v[102:103], v[6:7] op_sel_hi:[1,0]
    v_pk_mul_f32 v[104:105], v[104:105], v[6:7] op_sel_hi:[1,0]
    v_pk_mul_f32 v[106:107], v[106:107], v[6:7] op_sel_hi:[1,0]
    v_pk_mul_f32 v[108:109], v[108:109], v[6:7] op_sel_hi:[1,0]
    v_pk_mul_f32 v[110:111], v[110:111], v[6:7] op_sel_hi:[1,0]
    v_cvt_pk_bf16_f32 v176, v96, v97
    v_cvt_pk_bf16_f32 v177, v98, v99
    v_cvt_pk_bf16_f32 v178, v100, v101
    v_cvt_pk_bf16_f32 v179, v102, v103
    v_cvt_pk_bf16_f32 v180, v104, v105
    v_cvt_pk_bf16_f32 v181, v106, v107
    v_cvt_pk_bf16_f32 v182, v108, v109
    v_cvt_pk_bf16_f32 v183, v110, v111
    ds_write_b128 v202, v[176:179] offset:8192
    ds_write_b128 v203, v[180:183] offset:8192
    v_pk_mul_f32 v[80:81], v[80:81], v[8:9] op_sel_hi:[1,0]
    v_pk_mul_f32 v[82:83], v[82:83], v[8:9] op_sel_hi:[1,0]
    v_pk_mul_f32 v[84:85], v[84:85], v[8:9] op_sel_hi:[1,0]
    v_pk_mul_f32 v[86:87], v[86:87], v[8:9] op_sel_hi:[1,0]
    v_pk_mul_f32 v[88:89], v[88:89], v[8:9] op_sel_hi:[1,0]
    v_pk_mul_f32 v[90:91], v[90:91], v[8:9] op_sel_hi:[1,0]
    v_pk_mul_f32 v[92:93], v[92:93], v[8:9] op_sel_hi:[1,0]
    v_pk_mul_f32 v[94:95], v[94:95], v[8:9] op_sel_hi:[1,0]
    v_cvt_pk_bf16_f32 v184, v80, v81
    v_cvt_pk_bf16_f32 v185, v82, v83
    v_cvt_pk_bf16_f32 v186, v84, v85
    v_cvt_pk_bf16_f32 v187, v86, v87
    v_cvt_pk_bf16_f32 v188, v88, v89
    v_cvt_pk_bf16_f32 v189, v90, v91
    v_cvt_pk_bf16_f32 v190, v92, v93
    v_cvt_pk_bf16_f32 v191, v94, v95
    ds_write_b128 v202, v[184:187] offset:2048
    ds_write_b128 v203, v[188:191] offset:2048
    v_pk_mul_f32 v[112:113], v[112:113], v[10:11] op_sel_hi:[1,0]
    v_pk_mul_f32 v[114:115], v[114:115], v[10:11] op_sel_hi:[1,0]
    v_pk_mul_f32 v[116:117], v[116:117], v[10:11] op_sel_hi:[1,0]
    v_pk_mul_f32 v[118:119], v[118:119], v[10:11] op_sel_hi:[1,0]
    v_pk_mul_f32 v[120:121], v[120:121], v[10:11] op_sel_hi:[1,0]
    v_pk_mul_f32 v[122:123], v[122:123], v[10:11] op_sel_hi:[1,0]
    v_pk_mul_f32 v[124:125], v[124:125], v[10:11] op_sel_hi:[1,0]
    v_pk_mul_f32 v[126:127], v[126:127], v[10:11] op_sel_hi:[1,0]
    v_cvt_pk_bf16_f32 v192, v112, v113
    v_cvt_pk_bf16_f32 v193, v114, v115
    v_cvt_pk_bf16_f32 v194, v116, v117
    v_cvt_pk_bf16_f32 v195, v118, v119
    v_cvt_pk_bf16_f32 v196, v120, v121
    v_cvt_pk_bf16_f32 v197, v122, v123
    v_cvt_pk_bf16_f32 v198, v124, v125
    v_cvt_pk_bf16_f32 v199, v126, v127
    ds_write_b128 v202, v[192:195] offset:10240
    ds_write_b128 v203, v[196:199] offset:10240
    ds_write_b32 v242, v13 offset:384
    s_mov_b32 s82, 1048576
L_lw_e1:
    ds_read_b32 v243, v241 offset:384
    s_sub_u32 s82, s82, 1
    s_waitcnt lgkmcnt(0)
    v_cmp_ne_u32 vcc, 1, v243
    s_cmp_eq_u32 s82, 0
    s_cbranch_scc1 L_lwx_e1
    s_cbranch_vccnz L_lw_e1
L_lwx_e1:
    ds_read_b64_tr_b16 v[64:65], v204 offset:0
    ds_read_b64_tr_b16 v[66:67], v204 offset:1024
    ds_read_b128 v[96:99], v246 offset:0
    ds_read_b64_tr_b16 v[68:69], v205 offset:256
    ds_read_b64_tr_b16 v[70:71], v205 offset:1280
    ds_read_b128 v[100:103], v246 offset:1024
    ds_read_b64_tr_b16 v[72:73], v204 offset:2048
    ds_read_b64_tr_b16 v[74:75], v204 offset:3072
    ds_read_b128 v[104:107], v246 offset:2048
    ds_read_b64_tr_b16 v[76:77], v205 offset:2304
    ds_read_b64_tr_b16 v[78:79], v205 offset:3328
    ds_read_b128 v[108:111], v246 offset:3072
    s_waitcnt lgkmcnt(9)
    v_mfma_f32_32x32x16_bf16 v[128:143], v[64:67], v[96:99], 0
    ds_read_b64_tr_b16 v[80:81], v204 offset:4096
    ds_read_b64_tr_b16 v[82:83], v204 offset:5120
    ds_read_b128 v[112:115], v246 offset:4096
    s_waitcnt lgkmcnt(9)
    v_mfma_f32_32x32x16_bf16 v[128:143], v[68:71], v[100:103], v[128:143]
    ds_read_b64_tr_b16 v[84:85], v205 offset:4352
    ds_read_b64_tr_b16 v[86:87], v205 offset:5376
    ds_read_b128 v[116:119], v246 offset:5120
    s_waitcnt lgkmcnt(9)
    v_mfma_f32_32x32x16_bf16 v[128:143], v[72:75], v[104:107], v[128:143]
    ds_read_b64_tr_b16 v[88:89], v204 offset:6144
    ds_read_b64_tr_b16 v[90:91], v204 offset:7168
    ds_read_b128 v[120:123], v246 offset:6144
    s_waitcnt lgkmcnt(9)
    v_mfma_f32_32x32x16_bf16 v[128:143], v[76:79], v[108:111], v[128:143]
    ds_read_b64_tr_b16 v[92:93], v205 offset:6400
    ds_read_b64_tr_b16 v[94:95], v205 offset:7424
    ds_read_b128 v[124:127], v246 offset:7168
    s_waitcnt lgkmcnt(9)
    v_mfma_f32_32x32x16_bf16 v[128:143], v[80:83], v[112:115], v[128:143]
    s_waitcnt lgkmcnt(6)
    v_mfma_f32_32x32x16_bf16 v[128:143], v[84:87], v[116:119], v[128:143]
    s_waitcnt lgkmcnt(3)
    v_mfma_f32_32x32x16_bf16 v[128:143], v[88:91], v[120:123], v[128:143]
    s_waitcnt lgkmcnt(0)
    v_mfma_f32_32x32x16_bf16 v[128:143], v[92:95], v[124:127], v[128:143]
    s_nop 11
    ds_write_b128 v247, v[128:131] offset:0
    ds_write_b128 v247, v[132:135] offset:1024
    ds_write_b128 v247, v[136:139] offset:2048
    ds_write_b128 v247, v[140:143] offset:3072
L_k0:
    s_setprio 1
    s_lshl_b32 s60, s73, 11
    s_add_u32 s60, s60, 98304
    v_add_u32 v11, s60, v2
    v_xor_b32 v10, 0x800, v11
    s_lshl_b32 s60, s3, 14
    s_add_u32 s60, s60, 32768
    v_add_u32 v177, s60, v2
    v_mov_b32 v176, 0xdddddddd
    s_lshl_b32 s60, s52, 12
    s_add_u32 s60, s60, 65536
    v_add_u32 v178, s60, v2
    v_xor_b32 v179, 0x2000, v178
    s_and_b32 s60, s53, 1
    s_cselect_b32 s60, 16, 1
    v_mov_b32 v47, s60
    v_bfe_u32 v4, v1, 2, 2
    v_bfe_u32 v5, v1, 4, 1
    v_and_b32 v6, 3, v1
    v_lshlrev_b32 v6, 3, v6
    v_lshl_add_u32 v6, v4, 7, v6
    v_lshl_add_u32 v6, v3, 11, v6
    v_lshrrev_b32 v4, 1, v4
    v_lshl_add_u32 v6, v4, 5, v6
    v_add_u32 v6, 0, v6
    v_mul_u32_u24 v7, 576, v5
    v_add_u32 v32, v6, v7
    v_mul_u32_u24 v7, v7, v3
    v_sub_u32 v36, v32, v7
    v_xor_b32 v33, 32, v32
    v_xor_b32 v37, 32, v36
    v_xor_b32 v34, 64, v32
    v_xor_b32 v38, 64, v36
    v_xor_b32 v35, 96, v32
    v_xor_b32 v39, 96, v36
    s_lshr_b32 s60, s80, 1
    s_lshl_b32 s61, s85, 1
    s_add_u32 s60, s60, s61
    s_lshl_b32 s61, s60, 1
    s_add_u32 s61, s61, s81
    s_lshl_b32 s61, s61, 8
    s_add_u32 s24, s61, 14778368
    s_lshl_b32 s62, s81, 6
    s_add_u32 s60, s60, s62
    s_lshl_b32 s60, s60, 15
    s_and_b32 s62, s80, 1
    s_lshl_b32 s62, s62, 10
    s_add_u32 s60, s60, s62
    s_add_u32 s25, s60, 10485760
    s_xor_b32 s26, s25, 0x4000
    s_lshl_b32 s60, s52, 11
    s_add_u32 s60, s60, 81920
    v_and_b32 v4, 15, v1
    v_lshrrev_b32 v5, 4, v1
    v_and_b32 v6, 7, v1
    v_lshlrev_b32 v40, 4, v6
    v_lshl_add_u32 v40, v4, 7, v40
    v_lshlrev_b32 v5, 3, v5
    v_xor_b32 v40, v40, v5
    v_add_u32 v40, s60, v40
    v_lshrrev_b32 v4, 3, v1
    v_xor_b32 v44, v4, v6
    v_lshlrev_b32 v44, 4, v44
    v_lshl_add_u32 v44, v4, 7, v44
    v_add_u32 v44, s60, v44
    v_mul_u32_u24 v45, 1792, v4
    v_lshl_add_u32 v45, v6, 4, v45
    v_xor_b32 v41, 32, v40
    v_xor_b32 v42, 64, v40
    v_xor_b32 v43, 0x60, v40
    s_lshl_b32 s60, s85, 2
    s_add_u32 s60, s60, s80
    s_mul_i32 s60, s60, 28672
    s_mul_i32 s61, s81, 896
    s_add_u32 s60, s60, s61
    s_lshl_b32 s61, s83, 7
    s_add_u32 s28, s60, s61
    s_add_u32 s29, s28, 14336
    v_mov_b64 v[208:209], 0
    v_mov_b64 v[210:211], 0
    v_mov_b64 v[212:213], 0
    v_mov_b64 v[214:215], 0
    v_mov_b64 v[216:217], 0
    v_mov_b64 v[218:219], 0
    v_mov_b64 v[220:221], 0
    v_mov_b64 v[222:223], 0
    v_mov_b64 v[224:225], 0
    v_mov_b64 v[226:227], 0
    v_mov_b64 v[228:229], 0
    v_mov_b64 v[230:231], 0
    v_mov_b64 v[232:233], 0
    v_mov_b64 v[234:235], 0
    v_mov_b64 v[236:237], 0
    v_mov_b64 v[238:239], 0
    s_mov_b32 s70, 1
    s_waitcnt vmcnt(0) lgkmcnt(0)
    s_barrier
    ds_read_b128 v[16:19], v10
    ds_read_b128 v[160:163], v2 offset:32768
    ds_read_b128 v[20:23], v10 offset:1024
    ds_read_b128 v[164:167], v2 offset:33792
    ds_read_b128 v[24:27], v11
    ds_read_b128 v[28:31], v11 offset:1024
    ds_read_b128 v[128:131], v177 offset:0
    ds_read_b128 v[132:135], v177 offset:1024
    ds_read_b128 v[144:147], v177 offset:2048
    ds_read_b128 v[148:151], v177 offset:3072
    s_waitcnt lgkmcnt(8)
    v_mfma_f32_32x32x16_bf16 v[96:111], v[160:163], v[16:19], 0
    s_waitcnt lgkmcnt(6)
    v_mfma_f32_32x32x16_bf16 v[96:111], v[164:167], v[20:23], v[96:111]
    s_waitcnt lgkmcnt(4)
    v_mfma_f32_32x32x16_bf16 v[112:127], v[160:163], v[24:27], 0
    v_mfma_f32_32x32x16_bf16 v[112:127], v[164:167], v[28:31], v[112:127]
    s_waitcnt lgkmcnt(0)
    v_mfma_f32_32x32x16_bf16 v[64:79], v[128:131], v[16:19], 0
    s_nop 6
    v_max3_f32 v4, v96, v97, v98
    v_max3_f32 v5, v99, v100, v101
    v_max3_f32 v4, v4, v102, v103
    v_max3_f32 v5, v5, v104, v105
    v_max3_f32 v4, v4, v106, v107
    v_max3_f32 v5, v5, v108, v109
    v_max3_f32 v4, v4, v110, v111
    v_max_f32 v4, v4, v5
    v_mov_b32 v5, v4
    s_nop 1
    v_permlane32_swap_b32 v4, v5
    v_max_f32 v4, v4, v5
    v_sub_f32 v4, 0xc2c80000, v4
    s_mov_b64 exec, s[86:87]
    v_lshrrev_b32 v22, 16, v4
    s_mov_b64 exec, -1
    s_nop 0
    v_mfma_f32_32x32x16_bf16 v[64:79], v[132:135], v[20:23], v[64:79]
    v_max3_f32 v4, v112, v113, v114
    v_max3_f32 v5, v115, v116, v117
    v_max3_f32 v4, v4, v118, v119
    v_max3_f32 v5, v5, v120, v121
    v_max3_f32 v4, v4, v122, v123
    v_max3_f32 v5, v5, v124, v125
    v_max3_f32 v4, v4, v126, v127
    v_max_f32 v4, v4, v5
    v_mov_b32 v5, v4
    s_nop 1
    v_permlane32_swap_b32 v4, v5
    v_max_f32 v4, v4, v5
    v_sub_f32 v4, 0xc2c80000, v4
    s_mov_b64 exec, s[86:87]
    v_lshrrev_b32 v30, 16, v4
    s_mov_b64 exec, -1
.p2align 3
    v_mfma_f32_32x32x16_bf16 v[80:95], v[128:131], v[24:27], 0
    ds_read_b128 v[136:139], v177 offset:4096
    ds_read_b128 v[140:143], v177 offset:5120
    v_exp_f32 v96, v64
    v_exp_f32 v97, v65
    v_exp_f32 v98, v66
    v_exp_f32 v99, v67
    v_mfma_f32_32x32x16_bf16 v[80:95], v[132:135], v[28:31], v[80:95]
    ds_read_b128 v[152:155], v177 offset:6144
    ds_read_b128 v[156:159], v177 offset:7168
    v_exp_f32 v100, v68
    v_exp_f32 v101, v69
    v_exp_f32 v102, v70
    v_exp_f32 v103, v71
    ds_read_b32 v243, v241 offset:48
    v_exp_f32 v104, v72
    v_exp_f32 v105, v73
    v_exp_f32 v106, v74
    v_exp_f32 v107, v75
    v_exp_f32 v108, v76
    v_exp_f32 v109, v77
    v_exp_f32 v110, v78
    v_exp_f32 v111, v79
    s_waitcnt lgkmcnt(0)
    v_cmp_ne_u32 vcc, 1, v243
    v_mfma_f32_32x32x16_bf16 v[64:79], v[136:139], v[16:19], 0
    s_cbranch_vccnz L_slow_r0
L_back_r0:
    s_nop 0
    ds_read_b128 v[128:131], v177 offset:8192
    v_exp_f32 v112, v80
    v_exp_f32 v113, v81
    v_exp_f32 v114, v82
    v_exp_f32 v115, v83
    v_mfma_f32_32x32x16_bf16 v[64:79], v[140:143], v[20:23], v[64:79]
    ds_read_b128 v[132:135], v177 offset:9216
    v_exp_f32 v116, v84
    v_exp_f32 v117, v85
    v_exp_f32 v118, v86
    v_exp_f32 v119, v87
    v_smfmac_f32_32x32x32_bf16 v[208:223], v[144:147], v[96:103], v176
    ds_read_b128 v[160:163], v177 offset:10240
    v_exp_f32 v120, v88
    v_exp_f32 v121, v89
    v_exp_f32 v122, v90
    v_exp_f32 v123, v91
    v_smfmac_f32_32x32x32_bf16 v[208:223], v[148:151], v[104:111], v176
    ds_read_b128 v[164:167], v177 offset:11264
    v_exp_f32 v124, v92
    v_exp_f32 v125, v93
    v_exp_f32 v126, v94
    v_exp_f32 v127, v95
    v_mfma_f32_32x32x16_bf16 v[80:95], v[136:139], v[24:27], 0
    v_exp_f32 v96, v64
    v_exp_f32 v97, v65
    v_exp_f32 v98, v66
    v_exp_f32 v99, v67
    v_mfma_f32_32x32x16_bf16 v[80:95], v[140:143], v[28:31], v[80:95]
    v_exp_f32 v100, v68
    v_exp_f32 v101, v69
    v_exp_f32 v102, v70
    v_exp_f32 v103, v71
    v_smfmac_f32_32x32x32_bf16 v[224:239], v[144:147], v[112:119], v176
    v_exp_f32 v104, v72
    v_exp_f32 v105, v73
    v_exp_f32 v106, v74
    v_exp_f32 v107, v75
    v_smfmac_f32_32x32x32_bf16 v[224:239], v[148:151], v[120:127], v176
    v_exp_f32_e64 v108, v76
    v_exp_f32 v109, v77
    v_exp_f32 v110, v78
    v_exp_f32 v111, v79
    s_waitcnt lgkmcnt(0)
    v_mfma_f32_32x32x16_bf16 v[64:79], v[128:131], v[16:19], 0
    ds_read_b128 v[136:139], v177 offset:12288
    v_exp_f32 v112, v80
    v_exp_f32 v113, v81
    v_exp_f32 v114, v82
    v_exp_f32 v115, v83
    v_mfma_f32_32x32x16_bf16 v[64:79], v[132:135], v[20:23], v[64:79]
    ds_read_b128 v[140:143], v177 offset:13312
    v_exp_f32 v116, v84
    v_exp_f32 v117, v85
    v_exp_f32 v118, v86
    v_exp_f32 v119, v87
    v_smfmac_f32_32x32x32_bf16 v[208:223], v[152:155], v[96:103], v176
    ds_read_b128 v[168:171], v177 offset:14336
    v_exp_f32 v120, v88
    v_exp_f32 v121, v89
    v_exp_f32 v122, v90
    v_exp_f32 v123, v91
    v_smfmac_f32_32x32x32_bf16 v[208:223], v[156:159], v[104:111], v176
    ds_read_b128 v[172:175], v177 offset:15360
    v_exp_f32 v124, v92
    v_exp_f32 v125, v93
    v_exp_f32 v126, v94
    v_exp_f32 v127, v95
    v_mfma_f32_32x32x16_bf16 v[80:95], v[128:131], v[24:27], 0
    v_add_u32 v177, 32768, v177
    ds_read_b32 v243, v241 offset:80
    v_exp_f32 v96, v64
    v_exp_f32 v97, v65
    v_exp_f32 v98, v66
    v_exp_f32 v99, v67
    v_mfma_f32_32x32x16_bf16 v[80:95], v[132:135], v[28:31], v[80:95]
    v_exp_f32 v100, v68
    v_exp_f32 v101, v69
    v_exp_f32 v102, v70
    v_exp_f32 v103, v71
    v_smfmac_f32_32x32x32_bf16 v[224:239], v[152:155], v[112:119], v176
    v_exp_f32 v104, v72
    v_exp_f32 v105, v73
    v_exp_f32 v106, v74
    v_exp_f32 v107, v75
    v_smfmac_f32_32x32x32_bf16 v[224:239], v[156:159], v[120:127], v176
    v_exp_f32 v108, v76
    v_exp_f32 v109, v77
    v_exp_f32 v110, v78
    v_exp_f32 v111, v79
    s_waitcnt lgkmcnt(0)
    v_cmp_ne_u32 vcc, 1, v243
    v_mfma_f32_32x32x16_bf16 v[64:79], v[136:139], v[16:19], 0
    ds_write_b32 v242, v13 offset:256
    s_cbranch_vccnz L_slow_r1
L_back_r1:
    s_nop 0
    ds_read_b128 v[128:131], v177 offset:0
    v_exp_f32 v112, v80
    v_exp_f32 v113, v81
    v_exp_f32 v114, v82
    v_exp_f32 v115, v83
    v_mfma_f32_32x32x16_bf16 v[64:79], v[140:143], v[20:23], v[64:79]
    ds_read_b128 v[132:135], v177 offset:1024
    v_exp_f32 v116, v84
    v_exp_f32 v117, v85
    v_exp_f32 v118, v86
    v_exp_f32 v119, v87
    v_smfmac_f32_32x32x32_bf16 v[208:223], v[160:163], v[96:103], v176
    ds_read_b128 v[144:147], v177 offset:2048
    v_exp_f32 v120, v88
    v_exp_f32 v121, v89
    v_exp_f32 v122, v90
    v_exp_f32 v123, v91
    v_smfmac_f32_32x32x32_bf16 v[208:223], v[164:167], v[104:111], v176
    ds_read_b128 v[148:151], v177 offset:3072
    v_exp_f32 v124, v92
    v_exp_f32 v125, v93
    v_exp_f32 v126, v94
    v_exp_f32 v127, v95
    v_mfma_f32_32x32x16_bf16 v[80:95], v[136:139], v[24:27], 0
    v_exp_f32 v96, v64
    v_exp_f32 v97, v65
    v_exp_f32 v98, v66
    v_exp_f32 v99, v67
    v_mfma_f32_32x32x16_bf16 v[80:95], v[140:143], v[28:31], v[80:95]
    v_exp_f32 v100, v68
    v_exp_f32 v101, v69
    v_exp_f32 v102, v70
    v_exp_f32 v103, v71
    v_smfmac_f32_32x32x32_bf16 v[224:239], v[160:163], v[112:119], v176
    v_exp_f32 v104, v72
    v_exp_f32 v105, v73
    v_exp_f32 v106, v74
    v_exp_f32 v107, v75
    v_smfmac_f32_32x32x32_bf16 v[224:239], v[164:167], v[120:127], v176
    v_exp_f32_e64 v108, v76
    v_exp_f32 v109, v77
    v_exp_f32 v110, v78
    v_exp_f32 v111, v79
    s_waitcnt lgkmcnt(0)
    v_mfma_f32_32x32x16_bf16 v[64:79], v[128:131], v[16:19], 0
    ds_read_b128 v[136:139], v177 offset:4096
    v_exp_f32 v112, v80
    v_exp_f32 v113, v81
    v_exp_f32 v114, v82
    v_exp_f32 v115, v83
    v_mfma_f32_32x32x16_bf16 v[64:79], v[132:135], v[20:23], v[64:79]
    ds_read_b128 v[140:143], v177 offset:5120
    v_exp_f32 v116, v84
    v_exp_f32 v117, v85
    v_exp_f32 v118, v86
    v_exp_f32 v119, v87
    v_smfmac_f32_32x32x32_bf16 v[208:223], v[168:171], v[96:103], v176
    ds_read_b128 v[152:155], v177 offset:6144
    v_exp_f32 v120, v88
    v_exp_f32 v121, v89
    v_exp_f32 v122, v90
    v_exp_f32 v123, v91
    v_smfmac_f32_32x32x32_bf16 v[208:223], v[172:175], v[104:111], v176
    ds_read_b128 v[156:159], v177 offset:7168
    v_exp_f32 v124, v92
    v_exp_f32 v125, v93
    v_exp_f32 v126, v94
    v_exp_f32 v127, v95
    v_mfma_f32_32x32x16_bf16 v[80:95], v[128:131], v[24:27], 0
    v_exp_f32 v96, v64
    v_exp_f32 v97, v65
    v_exp_f32 v98, v66
    v_exp_f32 v99, v67
    v_mfma_f32_32x32x16_bf16 v[80:95], v[132:135], v[28:31], v[80:95]
    v_exp_f32 v100, v68
    v_exp_f32 v101, v69
    v_exp_f32 v102, v70
    v_exp_f32 v103, v71
    v_smfmac_f32_32x32x32_bf16 v[224:239], v[168:171], v[112:119], v176
    v_exp_f32 v104, v72
    v_exp_f32 v105, v73
    v_exp_f32 v106, v74
    v_exp_f32 v107, v75
    v_smfmac_f32_32x32x32_bf16 v[224:239], v[172:175], v[120:127], v176
    v_exp_f32_e64 v108, v76
    v_exp_f32 v109, v77
    v_exp_f32 v110, v78
    v_exp_f32 v111, v79
    s_waitcnt lgkmcnt(0)
    v_mfma_f32_32x32x16_bf16 v[64:79], v[136:139], v[16:19], 0
    ds_read_b128 v[128:131], v177 offset:8192
    v_exp_f32 v112, v80
    v_exp_f32 v113, v81
    v_exp_f32 v114, v82
    v_exp_f32 v115, v83
    v_mfma_f32_32x32x16_bf16 v[64:79], v[140:143], v[20:23], v[64:79]
    ds_read_b128 v[132:135], v177 offset:9216
    v_exp_f32 v116, v84
    v_exp_f32 v117, v85
    v_exp_f32 v118, v86
    v_exp_f32 v119, v87
    v_smfmac_f32_32x32x32_bf16 v[208:223], v[144:147], v[96:103], v176
    ds_read_b128 v[160:163], v177 offset:10240
    v_exp_f32 v120, v88
    v_exp_f32 v121, v89
    v_exp_f32 v122, v90
    v_exp_f32 v123, v91
    v_smfmac_f32_32x32x32_bf16 v[208:223], v[148:151], v[104:111], v176
    ds_read_b128 v[164:167], v177 offset:11264
    v_exp_f32 v124, v92
    v_exp_f32 v125, v93
    v_exp_f32 v126, v94
    v_exp_f32 v127, v95
    v_mfma_f32_32x32x16_bf16 v[80:95], v[136:139], v[24:27], 0
    v_exp_f32 v96, v64
    v_exp_f32 v97, v65
    v_exp_f32 v98, v66
    v_exp_f32 v99, v67
    v_mfma_f32_32x32x16_bf16 v[80:95], v[140:143], v[28:31], v[80:95]
    v_exp_f32 v100, v68
    v_exp_f32 v101, v69
    v_exp_f32 v102, v70
    v_exp_f32 v103, v71
    v_smfmac_f32_32x32x32_bf16 v[224:239], v[144:147], v[112:119], v176
    v_exp_f32 v104, v72
    v_exp_f32 v105, v73
    v_exp_f32 v106, v74
    v_exp_f32 v107, v75
    v_smfmac_f32_32x32x32_bf16 v[224:239], v[148:151], v[120:127], v176
    v_exp_f32_e64 v108, v76
    v_exp_f32 v109, v77
    v_exp_f32 v110, v78
    v_exp_f32 v111, v79
    s_waitcnt lgkmcnt(0)
    v_mfma_f32_32x32x16_bf16 v[64:79], v[128:131], v[16:19], 0
    ds_read_b128 v[136:139], v177 offset:12288
    v_exp_f32 v112, v80
    v_exp_f32 v113, v81
    v_exp_f32 v114, v82
    v_exp_f32 v115, v83
    v_mfma_f32_32x32x16_bf16 v[64:79], v[132:135], v[20:23], v[64:79]
    ds_read_b128 v[140:143], v177 offset:13312
    v_exp_f32 v116, v84
    v_exp_f32 v117, v85
    v_exp_f32 v118, v86
    v_exp_f32 v119, v87
    v_smfmac_f32_32x32x32_bf16 v[208:223], v[152:155], v[96:103], v176
    ds_read_b128 v[168:171], v177 offset:14336
    v_exp_f32 v120, v88
    v_exp_f32 v121, v89
    v_exp_f32 v122, v90
    v_exp_f32 v123, v91
    v_smfmac_f32_32x32x32_bf16 v[208:223], v[156:159], v[104:111], v176
    ds_read_b128 v[172:175], v177 offset:15360
    v_exp_f32 v124, v92
    v_exp_f32 v125, v93
    v_exp_f32 v126, v94
    v_exp_f32 v127, v95
    v_mfma_f32_32x32x16_bf16 v[80:95], v[128:131], v[24:27], 0
    v_add_u32 v177, 4294901760, v177
    ds_read_b32 v243, v241 offset:96
    v_exp_f32 v96, v64
    v_exp_f32 v97, v65
    v_exp_f32 v98, v66
    v_exp_f32 v99, v67
    v_mfma_f32_32x32x16_bf16 v[80:95], v[132:135], v[28:31], v[80:95]
    v_exp_f32 v100, v68
    v_exp_f32 v101, v69
    v_exp_f32 v102, v70
    v_exp_f32 v103, v71
    v_smfmac_f32_32x32x32_bf16 v[224:239], v[152:155], v[112:119], v176
    v_exp_f32 v104, v72
    v_exp_f32 v105, v73
    v_exp_f32 v106, v74
    v_exp_f32 v107, v75
    v_smfmac_f32_32x32x32_bf16 v[224:239], v[156:159], v[120:127], v176
    v_exp_f32 v108, v76
    v_exp_f32 v109, v77
    v_exp_f32 v110, v78
    v_exp_f32 v111, v79
    s_waitcnt lgkmcnt(0)
    v_cmp_ne_u32 vcc, 1, v243
    v_mfma_f32_32x32x16_bf16 v[64:79], v[136:139], v[16:19], 0
    ds_write_b32 v242, v13 offset:272
    s_cbranch_vccnz L_slow_r2
L_back_r2:
    s_nop 0
    ds_read_b128 v[128:131], v177 offset:0
    v_exp_f32 v112, v80
    v_exp_f32 v113, v81
    v_exp_f32 v114, v82
    v_exp_f32 v115, v83
    v_mfma_f32_32x32x16_bf16 v[64:79], v[140:143], v[20:23], v[64:79]
    ds_read_b128 v[132:135], v177 offset:1024
    v_exp_f32 v116, v84
    v_exp_f32 v117, v85
    v_exp_f32 v118, v86
    v_exp_f32 v119, v87
    v_smfmac_f32_32x32x32_bf16 v[208:223], v[160:163], v[96:103], v176
    ds_read_b128 v[144:147], v177 offset:2048
    v_exp_f32 v120, v88
    v_exp_f32 v121, v89
    v_exp_f32 v122, v90
    v_exp_f32 v123, v91
    v_smfmac_f32_32x32x32_bf16 v[208:223], v[164:167], v[104:111], v176
    ds_read_b128 v[148:151], v177 offset:3072
    v_exp_f32 v124, v92
    v_exp_f32 v125, v93
    v_exp_f32 v126, v94
    v_exp_f32 v127, v95
    v_mfma_f32_32x32x16_bf16 v[80:95], v[136:139], v[24:27], 0
    v_exp_f32 v96, v64
    v_exp_f32 v97, v65
    v_exp_f32 v98, v66
    v_exp_f32 v99, v67
    v_mfma_f32_32x32x16_bf16 v[80:95], v[140:143], v[28:31], v[80:95]
    v_exp_f32 v100, v68
    v_exp_f32 v101, v69
    v_exp_f32 v102, v70
    v_exp_f32 v103, v71
    v_smfmac_f32_32x32x32_bf16 v[224:239], v[160:163], v[112:119], v176
    v_exp_f32 v104, v72
    v_exp_f32 v105, v73
    v_exp_f32 v106, v74
    v_exp_f32 v107, v75
    v_smfmac_f32_32x32x32_bf16 v[224:239], v[164:167], v[120:127], v176
    v_exp_f32_e64 v108, v76
    v_exp_f32 v109, v77
    v_exp_f32 v110, v78
    v_exp_f32 v111, v79
    s_waitcnt lgkmcnt(0)
    v_mfma_f32_32x32x16_bf16 v[64:79], v[128:131], v[16:19], 0
    ds_read_b128 v[136:139], v177 offset:4096
    v_exp_f32 v112, v80
    v_exp_f32 v113, v81
    v_exp_f32 v114, v82
    v_exp_f32 v115, v83
    v_mfma_f32_32x32x16_bf16 v[64:79], v[132:135], v[20:23], v[64:79]
    ds_read_b128 v[140:143], v177 offset:5120
    v_exp_f32 v116, v84
    v_exp_f32 v117, v85
    v_exp_f32 v118, v86
    v_exp_f32 v119, v87
    v_smfmac_f32_32x32x32_bf16 v[208:223], v[168:171], v[96:103], v176
    ds_read_b128 v[152:155], v177 offset:6144
    v_exp_f32 v120, v88
    v_exp_f32 v121, v89
    v_exp_f32 v122, v90
    v_exp_f32 v123, v91
    v_smfmac_f32_32x32x32_bf16 v[208:223], v[172:175], v[104:111], v176
    ds_read_b128 v[156:159], v177 offset:7168
    v_exp_f32 v124, v92
    v_exp_f32 v125, v93
    v_exp_f32 v126, v94
    v_exp_f32 v127, v95
    v_mfma_f32_32x32x16_bf16 v[80:95], v[128:131], v[24:27], 0
    v_exp_f32 v96, v64
    v_exp_f32 v97, v65
    v_exp_f32 v98, v66
    v_exp_f32 v99, v67
    v_mfma_f32_32x32x16_bf16 v[80:95], v[132:135], v[28:31], v[80:95]
    v_exp_f32 v100, v68
    v_exp_f32 v101, v69
    v_exp_f32 v102, v70
    v_exp_f32 v103, v71
    v_smfmac_f32_32x32x32_bf16 v[224:239], v[168:171], v[112:119], v176
    v_exp_f32 v104, v72
    v_exp_f32 v105, v73
    v_exp_f32 v106, v74
    v_exp_f32 v107, v75
    v_smfmac_f32_32x32x32_bf16 v[224:239], v[172:175], v[120:127], v176
    v_exp_f32_e64 v108, v76
    v_exp_f32 v109, v77
    v_exp_f32 v110, v78
    v_exp_f32 v111, v79
    s_waitcnt lgkmcnt(0)
    v_mfma_f32_32x32x16_bf16 v[64:79], v[136:139], v[16:19], 0
    ds_read_b128 v[128:131], v177 offset:8192
    v_exp_f32 v112, v80
    v_exp_f32 v113, v81
    v_exp_f32 v114, v82
    v_exp_f32 v115, v83
    v_mfma_f32_32x32x16_bf16 v[64:79], v[140:143], v[20:23], v[64:79]
    ds_read_b128 v[132:135], v177 offset:9216
    v_exp_f32 v116, v84
    v_exp_f32 v117, v85
    v_exp_f32 v118, v86
    v_exp_f32 v119, v87
    v_smfmac_f32_32x32x32_bf16 v[208:223], v[144:147], v[96:103], v176
    ds_read_b128 v[160:163], v177 offset:10240
    v_exp_f32 v120, v88
    v_exp_f32 v121, v89
    v_exp_f32 v122, v90
    v_exp_f32 v123, v91
    v_smfmac_f32_32x32x32_bf16 v[208:223], v[148:151], v[104:111], v176
    ds_read_b128 v[164:167], v177 offset:11264
    v_exp_f32 v124, v92
    v_exp_f32 v125, v93
    v_exp_f32 v126, v94
    v_exp_f32 v127, v95
    v_mfma_f32_32x32x16_bf16 v[80:95], v[136:139], v[24:27], 0
    v_exp_f32 v96, v64
    v_exp_f32 v97, v65
    v_exp_f32 v98, v66
    v_exp_f32 v99, v67
    v_mfma_f32_32x32x16_bf16 v[80:95], v[140:143], v[28:31], v[80:95]
    v_exp_f32 v100, v68
    v_exp_f32 v101, v69
    v_exp_f32 v102, v70
    v_exp_f32 v103, v71
    v_smfmac_f32_32x32x32_bf16 v[224:239], v[144:147], v[112:119], v176
    v_exp_f32 v104, v72
    v_exp_f32 v105, v73
    v_exp_f32 v106, v74
    v_exp_f32 v107, v75
    v_smfmac_f32_32x32x32_bf16 v[224:239], v[148:151], v[120:127], v176
    v_exp_f32_e64 v108, v76
    v_exp_f32 v109, v77
    v_exp_f32 v110, v78
    v_exp_f32 v111, v79
    s_waitcnt lgkmcnt(0)
    v_mfma_f32_32x32x16_bf16 v[64:79], v[128:131], v[16:19], 0
    ds_read_b128 v[136:139], v177 offset:12288
    v_exp_f32 v112, v80
    v_exp_f32 v113, v81
    v_exp_f32 v114, v82
    v_exp_f32 v115, v83
    v_mfma_f32_32x32x16_bf16 v[64:79], v[132:135], v[20:23], v[64:79]
    ds_read_b128 v[140:143], v177 offset:13312
    v_exp_f32 v116, v84
    v_exp_f32 v117, v85
    v_exp_f32 v118, v86
    v_exp_f32 v119, v87
    v_smfmac_f32_32x32x32_bf16 v[208:223], v[152:155], v[96:103], v176
    ds_read_b128 v[168:171], v177 offset:14336
    v_exp_f32 v120, v88
    v_exp_f32 v121, v89
    v_exp_f32 v122, v90
    v_exp_f32 v123, v91
    v_smfmac_f32_32x32x32_bf16 v[208:223], v[156:159], v[104:111], v176
    ds_read_b128 v[172:175], v177 offset:15360
    v_exp_f32 v124, v92
    v_exp_f32 v125, v93
    v_exp_f32 v126, v94
    v_exp_f32 v127, v95
    v_mfma_f32_32x32x16_bf16 v[80:95], v[128:131], v[24:27], 0
    v_add_u32 v177, 32768, v177
    ds_read_b32 v243, v241 offset:112
    v_exp_f32 v96, v64
    v_exp_f32 v97, v65
    v_exp_f32 v98, v66
    v_exp_f32 v99, v67
    v_mfma_f32_32x32x16_bf16 v[80:95], v[132:135], v[28:31], v[80:95]
    v_exp_f32 v100, v68
    v_exp_f32 v101, v69
    v_exp_f32 v102, v70
    v_exp_f32 v103, v71
    v_smfmac_f32_32x32x32_bf16 v[224:239], v[152:155], v[112:119], v176
    v_exp_f32 v104, v72
    v_exp_f32 v105, v73
    v_exp_f32 v106, v74
    v_exp_f32 v107, v75
    v_smfmac_f32_32x32x32_bf16 v[224:239], v[156:159], v[120:127], v176
    v_exp_f32 v108, v76
    v_exp_f32 v109, v77
    v_exp_f32 v110, v78
    v_exp_f32 v111, v79
    s_waitcnt lgkmcnt(0)
    v_cmp_ne_u32 vcc, 1, v243
    v_mfma_f32_32x32x16_bf16 v[64:79], v[136:139], v[16:19], 0
    ds_write_b32 v242, v13 offset:288
    s_cbranch_vccnz L_slow_r3
L_back_r3:
    s_nop 0
    ds_read_b128 v[128:131], v177 offset:0
    v_exp_f32 v112, v80
    v_exp_f32 v113, v81
    v_exp_f32 v114, v82
    v_exp_f32 v115, v83
    v_mfma_f32_32x32x16_bf16 v[64:79], v[140:143], v[20:23], v[64:79]
    ds_read_b128 v[132:135], v177 offset:1024
    v_exp_f32 v116, v84
    v_exp_f32 v117, v85
    v_exp_f32 v118, v86
    v_exp_f32 v119, v87
    v_smfmac_f32_32x32x32_bf16 v[208:223], v[160:163], v[96:103], v176
    ds_read_b128 v[144:147], v177 offset:2048
    v_exp_f32 v120, v88
    v_exp_f32 v121, v89
    v_exp_f32 v122, v90
    v_exp_f32 v123, v91
    v_smfmac_f32_32x32x32_bf16 v[208:223], v[164:167], v[104:111], v176
    ds_read_b128 v[148:151], v177 offset:3072
    v_exp_f32 v124, v92
    v_exp_f32 v125, v93
    v_exp_f32 v126, v94
    v_exp_f32 v127, v95
    v_mfma_f32_32x32x16_bf16 v[80:95], v[136:139], v[24:27], 0
    v_exp_f32 v96, v64
    v_exp_f32 v97, v65
    v_exp_f32 v98, v66
    v_exp_f32 v99, v67
    v_mfma_f32_32x32x16_bf16 v[80:95], v[140:143], v[28:31], v[80:95]
    v_exp_f32 v100, v68
    v_exp_f32 v101, v69
    v_exp_f32 v102, v70
    v_exp_f32 v103, v71
    v_smfmac_f32_32x32x32_bf16 v[224:239], v[160:163], v[112:119], v176
    v_exp_f32 v104, v72
    v_exp_f32 v105, v73
    v_exp_f32 v106, v74
    v_exp_f32 v107, v75
    v_smfmac_f32_32x32x32_bf16 v[224:239], v[164:167], v[120:127], v176
    v_exp_f32_e64 v108, v76
    v_exp_f32 v109, v77
    v_exp_f32 v110, v78
    v_exp_f32 v111, v79
    s_waitcnt lgkmcnt(0)
    v_mfma_f32_32x32x16_bf16 v[64:79], v[128:131], v[16:19], 0
    ds_read_b128 v[136:139], v177 offset:4096
    v_exp_f32 v112, v80
    v_exp_f32 v113, v81
    v_exp_f32 v114, v82
    v_exp_f32 v115, v83
    v_mfma_f32_32x32x16_bf16 v[64:79], v[132:135], v[20:23], v[64:79]
    ds_read_b128 v[140:143], v177 offset:5120
    v_exp_f32 v116, v84
    v_exp_f32 v117, v85
    v_exp_f32 v118, v86
    v_exp_f32 v119, v87
    v_smfmac_f32_32x32x32_bf16 v[208:223], v[168:171], v[96:103], v176
    ds_read_b128 v[152:155], v177 offset:6144
    v_exp_f32 v120, v88
    v_exp_f32 v121, v89
    v_exp_f32 v122, v90
    v_exp_f32 v123, v91
    v_smfmac_f32_32x32x32_bf16 v[208:223], v[172:175], v[104:111], v176
    ds_read_b128 v[156:159], v177 offset:7168
    v_exp_f32 v124, v92
    v_exp_f32 v125, v93
    v_exp_f32 v126, v94
    v_exp_f32 v127, v95
    v_mfma_f32_32x32x16_bf16 v[80:95], v[128:131], v[24:27], 0
    v_exp_f32 v96, v64
    v_exp_f32 v97, v65
    v_exp_f32 v98, v66
    v_exp_f32 v99, v67
    v_mfma_f32_32x32x16_bf16 v[80:95], v[132:135], v[28:31], v[80:95]
    v_exp_f32 v100, v68
    v_exp_f32 v101, v69
    v_exp_f32 v102, v70
    v_exp_f32 v103, v71
    v_smfmac_f32_32x32x32_bf16 v[224:239], v[168:171], v[112:119], v176
    v_exp_f32 v104, v72
    v_exp_f32 v105, v73
    v_exp_f32 v106, v74
    v_exp_f32 v107, v75
    v_smfmac_f32_32x32x32_bf16 v[224:239], v[172:175], v[120:127], v176
    v_exp_f32_e64 v108, v76
    v_exp_f32 v109, v77
    v_exp_f32 v110, v78
    v_exp_f32 v111, v79
    s_waitcnt lgkmcnt(0)
    v_mfma_f32_32x32x16_bf16 v[64:79], v[136:139], v[16:19], 0
    ds_read_b128 v[128:131], v177 offset:8192
    v_exp_f32 v112, v80
    v_exp_f32 v113, v81
    v_exp_f32 v114, v82
    v_exp_f32 v115, v83
    v_mfma_f32_32x32x16_bf16 v[64:79], v[140:143], v[20:23], v[64:79]
    ds_read_b128 v[132:135], v177 offset:9216
    v_exp_f32 v116, v84
    v_exp_f32 v117, v85
    v_exp_f32 v118, v86
    v_exp_f32 v119, v87
    v_smfmac_f32_32x32x32_bf16 v[208:223], v[144:147], v[96:103], v176
    ds_read_b128 v[160:163], v177 offset:10240
    v_exp_f32 v120, v88
    v_exp_f32 v121, v89
    v_exp_f32 v122, v90
    v_exp_f32 v123, v91
    v_smfmac_f32_32x32x32_bf16 v[208:223], v[148:151], v[104:111], v176
    ds_read_b128 v[164:167], v177 offset:11264
    v_exp_f32 v124, v92
    v_exp_f32 v125, v93
    v_exp_f32 v126, v94
    v_exp_f32 v127, v95
    v_mfma_f32_32x32x16_bf16 v[80:95], v[136:139], v[24:27], 0
    v_exp_f32 v96, v64
    v_exp_f32 v97, v65
    v_exp_f32 v98, v66
    v_exp_f32 v99, v67
    v_mfma_f32_32x32x16_bf16 v[80:95], v[140:143], v[28:31], v[80:95]
    v_exp_f32 v100, v68
    v_exp_f32 v101, v69
    v_exp_f32 v102, v70
    v_exp_f32 v103, v71
    v_smfmac_f32_32x32x32_bf16 v[224:239], v[144:147], v[112:119], v176
    v_exp_f32 v104, v72
    v_exp_f32 v105, v73
    v_exp_f32 v106, v74
    v_exp_f32 v107, v75
    v_smfmac_f32_32x32x32_bf16 v[224:239], v[148:151], v[120:127], v176
    v_exp_f32_e64 v108, v76
    v_exp_f32 v109, v77
    v_exp_f32 v110, v78
    v_exp_f32 v111, v79
    s_waitcnt lgkmcnt(0)
    v_mfma_f32_32x32x16_bf16 v[64:79], v[128:131], v[16:19], 0
    ds_read_b128 v[136:139], v177 offset:12288
    v_exp_f32 v112, v80
    v_exp_f32 v113, v81
    v_exp_f32 v114, v82
    v_exp_f32 v115, v83
    v_mfma_f32_32x32x16_bf16 v[64:79], v[132:135], v[20:23], v[64:79]
    ds_read_b128 v[140:143], v177 offset:13312
    v_exp_f32 v116, v84
    v_exp_f32 v117, v85
    v_exp_f32 v118, v86
    v_exp_f32 v119, v87
    v_smfmac_f32_32x32x32_bf16 v[208:223], v[152:155], v[96:103], v176
    ds_read_b128 v[168:171], v177 offset:14336
    v_exp_f32 v120, v88
    v_exp_f32 v121, v89
    v_exp_f32 v122, v90
    v_exp_f32 v123, v91
    v_smfmac_f32_32x32x32_bf16 v[208:223], v[156:159], v[104:111], v176
    ds_read_b128 v[172:175], v177 offset:15360
    v_exp_f32 v124, v92
    v_exp_f32 v125, v93
    v_exp_f32 v126, v94
    v_exp_f32 v127, v95
    v_mfma_f32_32x32x16_bf16 v[80:95], v[128:131], v[24:27], 0
    v_add_u32 v177, 32768, v177
    ds_read_b32 v243, v241 offset:128
    v_exp_f32 v96, v64
    v_exp_f32 v97, v65
    v_exp_f32 v98, v66
    v_exp_f32 v99, v67
    v_mfma_f32_32x32x16_bf16 v[80:95], v[132:135], v[28:31], v[80:95]
    v_exp_f32 v100, v68
    v_exp_f32 v101, v69
    v_exp_f32 v102, v70
    v_exp_f32 v103, v71
    v_smfmac_f32_32x32x32_bf16 v[224:239], v[152:155], v[112:119], v176
    v_exp_f32 v104, v72
    v_exp_f32 v105, v73
    v_exp_f32 v106, v74
    v_exp_f32 v107, v75
    v_smfmac_f32_32x32x32_bf16 v[224:239], v[156:159], v[120:127], v176
    v_exp_f32 v108, v76
    v_exp_f32 v109, v77
    v_exp_f32 v110, v78
    v_exp_f32 v111, v79
    s_waitcnt lgkmcnt(0)
    v_cmp_ne_u32 vcc, 1, v243
    v_mfma_f32_32x32x16_bf16 v[64:79], v[136:139], v[16:19], 0
    ds_write_b32 v242, v13 offset:304
    s_cbranch_vccnz L_slow_r4
L_back_r4:
    s_nop 0
    ds_read_b128 v[128:131], v177 offset:0
    v_exp_f32 v112, v80
    v_exp_f32 v113, v81
    v_exp_f32 v114, v82
    v_exp_f32 v115, v83
    v_mfma_f32_32x32x16_bf16 v[64:79], v[140:143], v[20:23], v[64:79]
    ds_read_b128 v[132:135], v177 offset:1024
    v_exp_f32 v116, v84
    v_exp_f32 v117, v85
    v_exp_f32 v118, v86
    v_exp_f32 v119, v87
    v_smfmac_f32_32x32x32_bf16 v[208:223], v[160:163], v[96:103], v176
    ds_read_b128 v[144:147], v177 offset:2048
    v_exp_f32 v120, v88
    v_exp_f32 v121, v89
    v_exp_f32 v122, v90
    v_exp_f32 v123, v91
    v_smfmac_f32_32x32x32_bf16 v[208:223], v[164:167], v[104:111], v176
    ds_read_b128 v[148:151], v177 offset:3072
    v_exp_f32 v124, v92
    v_exp_f32 v125, v93
    v_exp_f32 v126, v94
    v_exp_f32 v127, v95
    v_mfma_f32_32x32x16_bf16 v[80:95], v[136:139], v[24:27], 0
    v_exp_f32 v96, v64
    v_exp_f32 v97, v65
    v_exp_f32 v98, v66
    v_exp_f32 v99, v67
    v_mfma_f32_32x32x16_bf16 v[80:95], v[140:143], v[28:31], v[80:95]
    v_exp_f32 v100, v68
    v_exp_f32 v101, v69
    v_exp_f32 v102, v70
    v_exp_f32 v103, v71
    v_smfmac_f32_32x32x32_bf16 v[224:239], v[160:163], v[112:119], v176
    v_exp_f32 v104, v72
    v_exp_f32 v105, v73
    v_exp_f32 v106, v74
    v_exp_f32 v107, v75
    v_smfmac_f32_32x32x32_bf16 v[224:239], v[164:167], v[120:127], v176
    v_exp_f32_e64 v108, v76
    v_exp_f32 v109, v77
    v_exp_f32 v110, v78
    v_exp_f32 v111, v79
    s_waitcnt lgkmcnt(0)
    v_mfma_f32_32x32x16_bf16 v[64:79], v[128:131], v[16:19], 0
    ds_read_b128 v[136:139], v177 offset:4096
    v_exp_f32 v112, v80
    v_exp_f32 v113, v81
    v_exp_f32 v114, v82
    v_exp_f32 v115, v83
    v_mfma_f32_32x32x16_bf16 v[64:79], v[132:135], v[20:23], v[64:79]
    ds_read_b128 v[140:143], v177 offset:5120
    v_exp_f32 v116, v84
    v_exp_f32 v117, v85
    v_exp_f32 v118, v86
    v_exp_f32 v119, v87
    v_smfmac_f32_32x32x32_bf16 v[208:223], v[168:171], v[96:103], v176
    ds_read_b128 v[152:155], v177 offset:6144
    v_exp_f32 v120, v88
    v_exp_f32 v121, v89
    v_exp_f32 v122, v90
    v_exp_f32 v123, v91
    v_smfmac_f32_32x32x32_bf16 v[208:223], v[172:175], v[104:111], v176
    ds_read_b128 v[156:159], v177 offset:7168
    v_exp_f32 v124, v92
    v_exp_f32 v125, v93
    v_exp_f32 v126, v94
    v_exp_f32 v127, v95
    v_mfma_f32_32x32x16_bf16 v[80:95], v[128:131], v[24:27], 0
    v_exp_f32 v96, v64
    v_exp_f32 v97, v65
    v_exp_f32 v98, v66
    v_exp_f32 v99, v67
    v_mfma_f32_32x32x16_bf16 v[80:95], v[132:135], v[28:31], v[80:95]
    v_exp_f32 v100, v68
    v_exp_f32 v101, v69
    v_exp_f32 v102, v70
    v_exp_f32 v103, v71
    v_smfmac_f32_32x32x32_bf16 v[224:239], v[168:171], v[112:119], v176
    v_exp_f32 v104, v72
    v_exp_f32 v105, v73
    v_exp_f32 v106, v74
    v_exp_f32 v107, v75
    v_smfmac_f32_32x32x32_bf16 v[224:239], v[172:175], v[120:127], v176
    v_exp_f32_e64 v108, v76
    v_exp_f32 v109, v77
    v_exp_f32 v110, v78
    v_exp_f32 v111, v79
    s_waitcnt lgkmcnt(0)
    v_mfma_f32_32x32x16_bf16 v[64:79], v[136:139], v[16:19], 0
    ds_read_b128 v[128:131], v177 offset:8192
    v_exp_f32 v112, v80
    v_exp_f32 v113, v81
    v_exp_f32 v114, v82
    v_exp_f32 v115, v83
    v_mfma_f32_32x32x16_bf16 v[64:79], v[140:143], v[20:23], v[64:79]
    ds_read_b128 v[132:135], v177 offset:9216
    v_exp_f32 v116, v84
    v_exp_f32 v117, v85
    v_exp_f32 v118, v86
    v_exp_f32 v119, v87
    v_smfmac_f32_32x32x32_bf16 v[208:223], v[144:147], v[96:103], v176
    ds_read_b128 v[160:163], v177 offset:10240
    v_exp_f32 v120, v88
    v_exp_f32 v121, v89
    v_exp_f32 v122, v90
    v_exp_f32 v123, v91
    v_smfmac_f32_32x32x32_bf16 v[208:223], v[148:151], v[104:111], v176
    ds_read_b128 v[164:167], v177 offset:11264
    v_exp_f32 v124, v92
    v_exp_f32 v125, v93
    v_exp_f32 v126, v94
    v_exp_f32 v127, v95
    v_mfma_f32_32x32x16_bf16 v[80:95], v[136:139], v[24:27], 0
    v_exp_f32 v96, v64
    v_exp_f32 v97, v65
    v_exp_f32 v98, v66
    v_exp_f32 v99, v67
    v_mfma_f32_32x32x16_bf16 v[80:95], v[140:143], v[28:31], v[80:95]
    v_exp_f32 v100, v68
    v_exp_f32 v101, v69
    v_exp_f32 v102, v70
    v_exp_f32 v103, v71
    v_smfmac_f32_32x32x32_bf16 v[224:239], v[144:147], v[112:119], v176
    v_exp_f32 v104, v72
    v_exp_f32 v105, v73
    v_exp_f32 v106, v74
    v_exp_f32 v107, v75
    v_smfmac_f32_32x32x32_bf16 v[224:239], v[148:151], v[120:127], v176
    v_exp_f32_e64 v108, v76
    v_exp_f32 v109, v77
    v_exp_f32 v110, v78
    v_exp_f32 v111, v79
    s_waitcnt lgkmcnt(0)
    v_mfma_f32_32x32x16_bf16 v[64:79], v[128:131], v[16:19], 0
    ds_read_b128 v[136:139], v177 offset:12288
    v_exp_f32 v112, v80
    v_exp_f32 v113, v81
    v_exp_f32 v114, v82
    v_exp_f32 v115, v83
    v_mfma_f32_32x32x16_bf16 v[64:79], v[132:135], v[20:23], v[64:79]
    ds_read_b128 v[140:143], v177 offset:13312
    v_exp_f32 v116, v84
    v_exp_f32 v117, v85
    v_exp_f32 v118, v86
    v_exp_f32 v119, v87
    v_smfmac_f32_32x32x32_bf16 v[208:223], v[152:155], v[96:103], v176
    ds_read_b128 v[168:171], v177 offset:14336
    v_exp_f32 v120, v88
    v_exp_f32 v121, v89
    v_exp_f32 v122, v90
    v_exp_f32 v123, v91
    v_smfmac_f32_32x32x32_bf16 v[208:223], v[156:159], v[104:111], v176
    ds_read_b128 v[172:175], v177 offset:15360
    v_exp_f32 v124, v92
    v_exp_f32 v125, v93
    v_exp_f32 v126, v94
    v_exp_f32 v127, v95
    v_mfma_f32_32x32x16_bf16 v[80:95], v[128:131], v[24:27], 0
    v_add_u32 v177, 4294901760, v177
    ds_read_b32 v243, v241 offset:144
    v_exp_f32 v96, v64
    v_exp_f32 v97, v65
    v_exp_f32 v98, v66
    v_exp_f32 v99, v67
    v_mfma_f32_32x32x16_bf16 v[80:95], v[132:135], v[28:31], v[80:95]
    v_exp_f32 v100, v68
    v_exp_f32 v101, v69
    v_exp_f32 v102, v70
    v_exp_f32 v103, v71
    v_smfmac_f32_32x32x32_bf16 v[224:239], v[152:155], v[112:119], v176
    v_exp_f32 v104, v72
    v_exp_f32 v105, v73
    v_exp_f32 v106, v74
    v_exp_f32 v107, v75
    v_smfmac_f32_32x32x32_bf16 v[224:239], v[156:159], v[120:127], v176
    v_exp_f32 v108, v76
    v_exp_f32 v109, v77
    v_exp_f32 v110, v78
    v_exp_f32 v111, v79
    s_waitcnt lgkmcnt(0)
    v_cmp_ne_u32 vcc, 1, v243
    v_mfma_f32_32x32x16_bf16 v[64:79], v[136:139], v[16:19], 0
    ds_write_b32 v242, v13 offset:320
    s_cbranch_vccnz L_slow_r5
L_back_r5:
    s_nop 0
    ds_read_b128 v[128:131], v177 offset:0
    v_exp_f32 v112, v80
    v_exp_f32 v113, v81
    v_exp_f32 v114, v82
    v_exp_f32 v115, v83
    v_mfma_f32_32x32x16_bf16 v[64:79], v[140:143], v[20:23], v[64:79]
    ds_read_b128 v[132:135], v177 offset:1024
    v_exp_f32 v116, v84
    v_exp_f32 v117, v85
    v_exp_f32 v118, v86
    v_exp_f32 v119, v87
    v_smfmac_f32_32x32x32_bf16 v[208:223], v[160:163], v[96:103], v176
    ds_read_b128 v[144:147], v177 offset:2048
    v_exp_f32 v120, v88
    v_exp_f32 v121, v89
    v_exp_f32 v122, v90
    v_exp_f32 v123, v91
    v_smfmac_f32_32x32x32_bf16 v[208:223], v[164:167], v[104:111], v176
    ds_read_b128 v[148:151], v177 offset:3072
    v_exp_f32 v124, v92
    v_exp_f32 v125, v93
    v_exp_f32 v126, v94
    v_exp_f32 v127, v95
    v_mfma_f32_32x32x16_bf16 v[80:95], v[136:139], v[24:27], 0
    v_exp_f32 v96, v64
    v_exp_f32 v97, v65
    v_exp_f32 v98, v66
    v_exp_f32 v99, v67
    v_mfma_f32_32x32x16_bf16 v[80:95], v[140:143], v[28:31], v[80:95]
    v_exp_f32 v100, v68
    v_exp_f32 v101, v69
    v_exp_f32 v102, v70
    v_exp_f32 v103, v71
    v_smfmac_f32_32x32x32_bf16 v[224:239], v[160:163], v[112:119], v176
    v_exp_f32 v104, v72
    v_exp_f32 v105, v73
    v_exp_f32 v106, v74
    v_exp_f32 v107, v75
    v_smfmac_f32_32x32x32_bf16 v[224:239], v[164:167], v[120:127], v176
    v_exp_f32_e64 v108, v76
    v_exp_f32 v109, v77
    v_exp_f32 v110, v78
    v_exp_f32 v111, v79
    s_waitcnt lgkmcnt(0)
    v_mfma_f32_32x32x16_bf16 v[64:79], v[128:131], v[16:19], 0
    ds_read_b128 v[136:139], v177 offset:4096
    v_exp_f32 v112, v80
    v_exp_f32 v113, v81
    v_exp_f32 v114, v82
    v_exp_f32 v115, v83
    v_mfma_f32_32x32x16_bf16 v[64:79], v[132:135], v[20:23], v[64:79]
    ds_read_b128 v[140:143], v177 offset:5120
    v_exp_f32 v116, v84
    v_exp_f32 v117, v85
    v_exp_f32 v118, v86
    v_exp_f32 v119, v87
    v_smfmac_f32_32x32x32_bf16 v[208:223], v[168:171], v[96:103], v176
    ds_read_b128 v[152:155], v177 offset:6144
    v_exp_f32 v120, v88
    v_exp_f32 v121, v89
    v_exp_f32 v122, v90
    v_exp_f32 v123, v91
    v_smfmac_f32_32x32x32_bf16 v[208:223], v[172:175], v[104:111], v176
    ds_read_b128 v[156:159], v177 offset:7168
    v_exp_f32 v124, v92
    v_exp_f32 v125, v93
    v_exp_f32 v126, v94
    v_exp_f32 v127, v95
    v_mfma_f32_32x32x16_bf16 v[80:95], v[128:131], v[24:27], 0
    v_exp_f32 v96, v64
    v_exp_f32 v97, v65
    v_exp_f32 v98, v66
    v_exp_f32 v99, v67
    v_mfma_f32_32x32x16_bf16 v[80:95], v[132:135], v[28:31], v[80:95]
    v_exp_f32 v100, v68
    v_exp_f32 v101, v69
    v_exp_f32 v102, v70
    v_exp_f32 v103, v71
    v_smfmac_f32_32x32x32_bf16 v[224:239], v[168:171], v[112:119], v176
    v_exp_f32 v104, v72
    v_exp_f32 v105, v73
    v_exp_f32 v106, v74
    v_exp_f32 v107, v75
    v_smfmac_f32_32x32x32_bf16 v[224:239], v[172:175], v[120:127], v176
    v_exp_f32_e64 v108, v76
    v_exp_f32 v109, v77
    v_exp_f32 v110, v78
    v_exp_f32 v111, v79
    s_waitcnt lgkmcnt(0)
    v_mfma_f32_32x32x16_bf16 v[64:79], v[136:139], v[16:19], 0
    ds_read_b128 v[128:131], v177 offset:8192
    v_exp_f32 v112, v80
    v_exp_f32 v113, v81
    v_exp_f32 v114, v82
    v_exp_f32 v115, v83
    v_mfma_f32_32x32x16_bf16 v[64:79], v[140:143], v[20:23], v[64:79]
    ds_read_b128 v[132:135], v177 offset:9216
    v_exp_f32 v116, v84
    v_exp_f32 v117, v85
    v_exp_f32 v118, v86
    v_exp_f32 v119, v87
    v_smfmac_f32_32x32x32_bf16 v[208:223], v[144:147], v[96:103], v176
    ds_read_b128 v[160:163], v177 offset:10240
    v_exp_f32 v120, v88
    v_exp_f32 v121, v89
    v_exp_f32 v122, v90
    v_exp_f32 v123, v91
    v_smfmac_f32_32x32x32_bf16 v[208:223], v[148:151], v[104:111], v176
    ds_read_b128 v[164:167], v177 offset:11264
    v_exp_f32 v124, v92
    v_exp_f32 v125, v93
    v_exp_f32 v126, v94
    v_exp_f32 v127, v95
    v_mfma_f32_32x32x16_bf16 v[80:95], v[136:139], v[24:27], 0
    v_exp_f32 v96, v64
    v_exp_f32 v97, v65
    v_exp_f32 v98, v66
    v_exp_f32 v99, v67
    v_mfma_f32_32x32x16_bf16 v[80:95], v[140:143], v[28:31], v[80:95]
    v_exp_f32 v100, v68
    v_exp_f32 v101, v69
    v_exp_f32 v102, v70
    v_exp_f32 v103, v71
    v_smfmac_f32_32x32x32_bf16 v[224:239], v[144:147], v[112:119], v176
    v_exp_f32 v104, v72
    v_exp_f32 v105, v73
    v_exp_f32 v106, v74
    v_exp_f32 v107, v75
    v_smfmac_f32_32x32x32_bf16 v[224:239], v[148:151], v[120:127], v176
    v_exp_f32_e64 v108, v76
    v_exp_f32 v109, v77
    v_exp_f32 v110, v78
    v_exp_f32 v111, v79
    s_waitcnt lgkmcnt(0)
    v_mfma_f32_32x32x16_bf16 v[64:79], v[128:131], v[16:19], 0
    ds_read_b128 v[136:139], v177 offset:12288
    v_exp_f32 v112, v80
    v_exp_f32 v113, v81
    v_exp_f32 v114, v82
    v_exp_f32 v115, v83
    v_mfma_f32_32x32x16_bf16 v[64:79], v[132:135], v[20:23], v[64:79]
    ds_read_b128 v[140:143], v177 offset:13312
    v_exp_f32 v116, v84
    v_exp_f32 v117, v85
    v_exp_f32 v118, v86
    v_exp_f32 v119, v87
    v_smfmac_f32_32x32x32_bf16 v[208:223], v[152:155], v[96:103], v176
    ds_read_b128 v[168:171], v177 offset:14336
    v_exp_f32 v120, v88
    v_exp_f32 v121, v89
    v_exp_f32 v122, v90
    v_exp_f32 v123, v91
    v_smfmac_f32_32x32x32_bf16 v[208:223], v[156:159], v[104:111], v176
    ds_read_b128 v[172:175], v177 offset:15360
    v_exp_f32 v124, v92
    v_exp_f32 v125, v93
    v_exp_f32 v126, v94
    v_exp_f32 v127, v95
    v_mfma_f32_32x32x16_bf16 v[80:95], v[128:131], v[24:27], 0
    v_add_u32 v177, 32768, v177
    ds_read_b32 v243, v241 offset:160
    v_exp_f32 v96, v64
    v_exp_f32 v97, v65
    v_exp_f32 v98, v66
    v_exp_f32 v99, v67
    v_mfma_f32_32x32x16_bf16 v[80:95], v[132:135], v[28:31], v[80:95]
    v_exp_f32 v100, v68
    v_exp_f32 v101, v69
    v_exp_f32 v102, v70
    v_exp_f32 v103, v71
    v_smfmac_f32_32x32x32_bf16 v[224:239], v[152:155], v[112:119], v176
    v_exp_f32 v104, v72
    v_exp_f32 v105, v73
    v_exp_f32 v106, v74
    v_exp_f32 v107, v75
    v_smfmac_f32_32x32x32_bf16 v[224:239], v[156:159], v[120:127], v176
    v_exp_f32 v108, v76
    v_exp_f32 v109, v77
    v_exp_f32 v110, v78
    v_exp_f32 v111, v79
    s_waitcnt lgkmcnt(0)
    v_cmp_ne_u32 vcc, 1, v243
    v_mfma_f32_32x32x16_bf16 v[64:79], v[136:139], v[16:19], 0
    ds_write_b32 v242, v13 offset:336
    s_cbranch_vccnz L_slow_r6
L_back_r6:
    s_nop 0
    ds_read_b128 v[128:131], v177 offset:0
    v_exp_f32 v112, v80
    v_exp_f32 v113, v81
    v_exp_f32 v114, v82
    v_exp_f32 v115, v83
    v_mfma_f32_32x32x16_bf16 v[64:79], v[140:143], v[20:23], v[64:79]
    ds_read_b128 v[132:135], v177 offset:1024
    v_exp_f32 v116, v84
    v_exp_f32 v117, v85
    v_exp_f32 v118, v86
    v_exp_f32 v119, v87
    v_smfmac_f32_32x32x32_bf16 v[208:223], v[160:163], v[96:103], v176
    ds_read_b128 v[144:147], v177 offset:2048
    v_exp_f32 v120, v88
    v_exp_f32 v121, v89
    v_exp_f32 v122, v90
    v_exp_f32 v123, v91
    v_smfmac_f32_32x32x32_bf16 v[208:223], v[164:167], v[104:111], v176
    ds_read_b128 v[148:151], v177 offset:3072
    v_exp_f32 v124, v92
    v_exp_f32 v125, v93
    v_exp_f32 v126, v94
    v_exp_f32 v127, v95
    v_mfma_f32_32x32x16_bf16 v[80:95], v[136:139], v[24:27], 0
    v_exp_f32 v96, v64
    v_exp_f32 v97, v65
    v_exp_f32 v98, v66
    v_exp_f32 v99, v67
    v_mfma_f32_32x32x16_bf16 v[80:95], v[140:143], v[28:31], v[80:95]
    v_exp_f32 v100, v68
    v_exp_f32 v101, v69
    v_exp_f32 v102, v70
    v_exp_f32 v103, v71
    v_smfmac_f32_32x32x32_bf16 v[224:239], v[160:163], v[112:119], v176
    v_exp_f32 v104, v72
    v_exp_f32 v105, v73
    v_exp_f32 v106, v74
    v_exp_f32 v107, v75
    v_smfmac_f32_32x32x32_bf16 v[224:239], v[164:167], v[120:127], v176
    v_exp_f32_e64 v108, v76
    v_exp_f32 v109, v77
    v_exp_f32 v110, v78
    v_exp_f32 v111, v79
    s_waitcnt lgkmcnt(0)
    v_mfma_f32_32x32x16_bf16 v[64:79], v[128:131], v[16:19], 0
    ds_read_b128 v[136:139], v177 offset:4096
    v_exp_f32 v112, v80
    v_exp_f32 v113, v81
    v_exp_f32 v114, v82
    v_exp_f32 v115, v83
    v_mfma_f32_32x32x16_bf16 v[64:79], v[132:135], v[20:23], v[64:79]
    ds_read_b128 v[140:143], v177 offset:5120
    v_exp_f32 v116, v84
    v_exp_f32 v117, v85
    v_exp_f32 v118, v86
    v_exp_f32 v119, v87
    v_smfmac_f32_32x32x32_bf16 v[208:223], v[168:171], v[96:103], v176
    ds_read_b128 v[152:155], v177 offset:6144
    v_exp_f32 v120, v88
    v_exp_f32 v121, v89
    v_exp_f32 v122, v90
    v_exp_f32 v123, v91
    v_smfmac_f32_32x32x32_bf16 v[208:223], v[172:175], v[104:111], v176
    ds_read_b128 v[156:159], v177 offset:7168
    v_exp_f32 v124, v92
    v_exp_f32 v125, v93
    v_exp_f32 v126, v94
    v_exp_f32 v127, v95
    v_mfma_f32_32x32x16_bf16 v[80:95], v[128:131], v[24:27], 0
    v_exp_f32 v96, v64
    v_exp_f32 v97, v65
    v_exp_f32 v98, v66
    v_exp_f32 v99, v67
    v_mfma_f32_32x32x16_bf16 v[80:95], v[132:135], v[28:31], v[80:95]
    v_exp_f32 v100, v68
    v_exp_f32 v101, v69
    v_exp_f32 v102, v70
    v_exp_f32 v103, v71
    v_smfmac_f32_32x32x32_bf16 v[224:239], v[168:171], v[112:119], v176
    v_exp_f32 v104, v72
    v_exp_f32 v105, v73
    v_exp_f32 v106, v74
    v_exp_f32 v107, v75
    v_smfmac_f32_32x32x32_bf16 v[224:239], v[172:175], v[120:127], v176
    v_exp_f32_e64 v108, v76
    v_exp_f32 v109, v77
    v_exp_f32 v110, v78
    v_exp_f32 v111, v79
    s_waitcnt lgkmcnt(0)
    v_mfma_f32_32x32x16_bf16 v[64:79], v[136:139], v[16:19], 0
    ds_read_b128 v[128:131], v177 offset:8192
    v_exp_f32 v112, v80
    v_exp_f32 v113, v81
    v_exp_f32 v114, v82
    v_exp_f32 v115, v83
    v_mfma_f32_32x32x16_bf16 v[64:79], v[140:143], v[20:23], v[64:79]
    ds_read_b128 v[132:135], v177 offset:9216
    v_exp_f32 v116, v84
    v_exp_f32 v117, v85
    v_exp_f32 v118, v86
    v_exp_f32 v119, v87
    v_smfmac_f32_32x32x32_bf16 v[208:223], v[144:147], v[96:103], v176
    ds_read_b128 v[160:163], v177 offset:10240
    v_exp_f32 v120, v88
    v_exp_f32 v121, v89
    v_exp_f32 v122, v90
    v_exp_f32 v123, v91
    v_smfmac_f32_32x32x32_bf16 v[208:223], v[148:151], v[104:111], v176
    ds_read_b128 v[164:167], v177 offset:11264
    v_exp_f32 v124, v92
    v_exp_f32 v125, v93
    v_exp_f32 v126, v94
    v_exp_f32 v127, v95
    v_mfma_f32_32x32x16_bf16 v[80:95], v[136:139], v[24:27], 0
    v_exp_f32 v96, v64
    v_exp_f32 v97, v65
    v_exp_f32 v98, v66
    v_exp_f32 v99, v67
    v_mfma_f32_32x32x16_bf16 v[80:95], v[140:143], v[28:31], v[80:95]
    v_exp_f32 v100, v68
    v_exp_f32 v101, v69
    v_exp_f32 v102, v70
    v_exp_f32 v103, v71
    v_smfmac_f32_32x32x32_bf16 v[224:239], v[144:147], v[112:119], v176
    v_exp_f32 v104, v72
    v_exp_f32 v105, v73
    v_exp_f32 v106, v74
    v_exp_f32 v107, v75
    v_smfmac_f32_32x32x32_bf16 v[224:239], v[148:151], v[120:127], v176
    v_exp_f32_e64 v108, v76
    v_exp_f32 v109, v77
    v_exp_f32 v110, v78
    v_exp_f32 v111, v79
    s_waitcnt lgkmcnt(0)
    v_mfma_f32_32x32x16_bf16 v[64:79], v[128:131], v[16:19], 0
    ds_read_b128 v[136:139], v177 offset:12288
    v_exp_f32 v112, v80
    v_exp_f32 v113, v81
    v_exp_f32 v114, v82
    v_exp_f32 v115, v83
    v_mfma_f32_32x32x16_bf16 v[64:79], v[132:135], v[20:23], v[64:79]
    ds_read_b128 v[140:143], v177 offset:13312
    v_exp_f32 v116, v84
    v_exp_f32 v117, v85
    v_exp_f32 v118, v86
    v_exp_f32 v119, v87
    v_smfmac_f32_32x32x32_bf16 v[208:223], v[152:155], v[96:103], v176
    ds_read_b128 v[168:171], v177 offset:14336
    v_exp_f32 v120, v88
    v_exp_f32 v121, v89
    v_exp_f32 v122, v90
    v_exp_f32 v123, v91
    v_smfmac_f32_32x32x32_bf16 v[208:223], v[156:159], v[104:111], v176
    ds_read_b128 v[172:175], v177 offset:15360
    v_exp_f32 v124, v92
    v_exp_f32 v125, v93
    v_exp_f32 v126, v94
    v_exp_f32 v127, v95
    v_mfma_f32_32x32x16_bf16 v[80:95], v[128:131], v[24:27], 0
    v_add_u32 v177, 32768, v177
    ds_read_b32 v243, v241 offset:176
    v_exp_f32 v96, v64
    v_exp_f32 v97, v65
    v_exp_f32 v98, v66
    v_exp_f32 v99, v67
    v_mfma_f32_32x32x16_bf16 v[80:95], v[132:135], v[28:31], v[80:95]
    v_exp_f32 v100, v68
    v_exp_f32 v101, v69
    v_exp_f32 v102, v70
    v_exp_f32 v103, v71
    v_smfmac_f32_32x32x32_bf16 v[224:239], v[152:155], v[112:119], v176
    v_exp_f32 v104, v72
    v_exp_f32 v105, v73
    v_exp_f32 v106, v74
    v_exp_f32 v107, v75
    v_smfmac_f32_32x32x32_bf16 v[224:239], v[156:159], v[120:127], v176
    v_exp_f32 v108, v76
    v_exp_f32 v109, v77
    v_exp_f32 v110, v78
    v_exp_f32 v111, v79
    s_waitcnt lgkmcnt(0)
    v_cmp_ne_u32 vcc, 1, v243
    v_mfma_f32_32x32x16_bf16 v[64:79], v[136:139], v[16:19], 0
    ds_write_b32 v242, v13 offset:352
    s_cbranch_vccnz L_slow_r7
L_back_r7:
    s_nop 0
    ds_read_b128 v[128:131], v177 offset:0
    v_exp_f32 v112, v80
    v_exp_f32 v113, v81
    v_exp_f32 v114, v82
    v_exp_f32 v115, v83
    v_mfma_f32_32x32x16_bf16 v[64:79], v[140:143], v[20:23], v[64:79]
    ds_read_b128 v[132:135], v177 offset:1024
    v_exp_f32 v116, v84
    v_exp_f32 v117, v85
    v_exp_f32 v118, v86
    v_exp_f32 v119, v87
    v_smfmac_f32_32x32x32_bf16 v[208:223], v[160:163], v[96:103], v176
    ds_read_b128 v[144:147], v177 offset:2048
    v_exp_f32 v120, v88
    v_exp_f32 v121, v89
    v_exp_f32 v122, v90
    v_exp_f32 v123, v91
    v_smfmac_f32_32x32x32_bf16 v[208:223], v[164:167], v[104:111], v176
    ds_read_b128 v[148:151], v177 offset:3072
    v_exp_f32 v124, v92
    v_exp_f32 v125, v93
    v_exp_f32 v126, v94
    v_exp_f32 v127, v95
    v_mfma_f32_32x32x16_bf16 v[80:95], v[136:139], v[24:27], 0
    v_exp_f32 v96, v64
    v_exp_f32 v97, v65
    v_exp_f32 v98, v66
    v_exp_f32 v99, v67
    v_mfma_f32_32x32x16_bf16 v[80:95], v[140:143], v[28:31], v[80:95]
    v_exp_f32 v100, v68
    v_exp_f32 v101, v69
    v_exp_f32 v102, v70
    v_exp_f32 v103, v71
    v_smfmac_f32_32x32x32_bf16 v[224:239], v[160:163], v[112:119], v176
    v_exp_f32 v104, v72
    v_exp_f32 v105, v73
    v_exp_f32 v106, v74
    v_exp_f32 v107, v75
    v_smfmac_f32_32x32x32_bf16 v[224:239], v[164:167], v[120:127], v176
    v_exp_f32_e64 v108, v76
    v_exp_f32 v109, v77
    v_exp_f32 v110, v78
    v_exp_f32 v111, v79
    s_waitcnt lgkmcnt(0)
    v_mfma_f32_32x32x16_bf16 v[64:79], v[128:131], v[16:19], 0
    ds_read_b128 v[136:139], v177 offset:4096
    v_exp_f32 v112, v80
    v_exp_f32 v113, v81
    v_exp_f32 v114, v82
    v_exp_f32 v115, v83
    v_mfma_f32_32x32x16_bf16 v[64:79], v[132:135], v[20:23], v[64:79]
    ds_read_b128 v[140:143], v177 offset:5120
    v_exp_f32 v116, v84
    v_exp_f32 v117, v85
    v_exp_f32 v118, v86
    v_exp_f32 v119, v87
    v_smfmac_f32_32x32x32_bf16 v[208:223], v[168:171], v[96:103], v176
    ds_read_b128 v[152:155], v177 offset:6144
    v_exp_f32 v120, v88
    v_exp_f32 v121, v89
    v_exp_f32 v122, v90
    v_exp_f32 v123, v91
    v_smfmac_f32_32x32x32_bf16 v[208:223], v[172:175], v[104:111], v176
    ds_read_b128 v[156:159], v177 offset:7168
    v_exp_f32 v124, v92
    v_exp_f32 v125, v93
    v_exp_f32 v126, v94
    v_exp_f32 v127, v95
    v_mfma_f32_32x32x16_bf16 v[80:95], v[128:131], v[24:27], 0
    v_exp_f32 v96, v64
    v_exp_f32 v97, v65
    v_exp_f32 v98, v66
    v_exp_f32 v99, v67
    v_mfma_f32_32x32x16_bf16 v[80:95], v[132:135], v[28:31], v[80:95]
    v_exp_f32 v100, v68
    v_exp_f32 v101, v69
    v_exp_f32 v102, v70
    v_exp_f32 v103, v71
    v_smfmac_f32_32x32x32_bf16 v[224:239], v[168:171], v[112:119], v176
    v_exp_f32 v104, v72
    v_exp_f32 v105, v73
    v_exp_f32 v106, v74
    v_exp_f32 v107, v75
    v_smfmac_f32_32x32x32_bf16 v[224:239], v[172:175], v[120:127], v176
    v_exp_f32_e64 v108, v76
    v_exp_f32 v109, v77
    v_exp_f32 v110, v78
    v_exp_f32 v111, v79
    s_waitcnt lgkmcnt(0)
    v_mfma_f32_32x32x16_bf16 v[64:79], v[136:139], v[16:19], 0
    ds_read_b128 v[128:131], v177 offset:8192
    v_exp_f32 v112, v80
    v_exp_f32 v113, v81
    v_exp_f32 v114, v82
    v_exp_f32 v115, v83
    v_mfma_f32_32x32x16_bf16 v[64:79], v[140:143], v[20:23], v[64:79]
    ds_read_b128 v[132:135], v177 offset:9216
    v_exp_f32 v116, v84
    v_exp_f32 v117, v85
    v_exp_f32 v118, v86
    v_exp_f32 v119, v87
    v_smfmac_f32_32x32x32_bf16 v[208:223], v[144:147], v[96:103], v176
    ds_read_b128 v[160:163], v177 offset:10240
    v_exp_f32 v120, v88
    v_exp_f32 v121, v89
    v_exp_f32 v122, v90
    v_exp_f32 v123, v91
    v_smfmac_f32_32x32x32_bf16 v[208:223], v[148:151], v[104:111], v176
    ds_read_b128 v[164:167], v177 offset:11264
    v_exp_f32 v124, v92
    v_exp_f32 v125, v93
    v_exp_f32 v126, v94
    v_exp_f32 v127, v95
    v_mfma_f32_32x32x16_bf16 v[80:95], v[136:139], v[24:27], 0
    v_exp_f32 v96, v64
    v_exp_f32 v97, v65
    v_exp_f32 v98, v66
    v_exp_f32 v99, v67
    v_mfma_f32_32x32x16_bf16 v[80:95], v[140:143], v[28:31], v[80:95]
    v_exp_f32 v100, v68
    v_exp_f32 v101, v69
    v_exp_f32 v102, v70
    v_exp_f32 v103, v71
    v_smfmac_f32_32x32x32_bf16 v[224:239], v[144:147], v[112:119], v176
    v_exp_f32 v104, v72
    v_exp_f32 v105, v73
    v_exp_f32 v106, v74
    v_exp_f32 v107, v75
    v_smfmac_f32_32x32x32_bf16 v[224:239], v[148:151], v[120:127], v176
    v_exp_f32_e64 v108, v76
    v_exp_f32 v109, v77
    v_exp_f32 v110, v78
    v_exp_f32 v111, v79
    s_waitcnt lgkmcnt(0)
    v_mfma_f32_32x32x16_bf16 v[64:79], v[128:131], v[16:19], 0
    ds_read_b128 v[136:139], v177 offset:12288
    v_exp_f32 v112, v80
    v_exp_f32 v113, v81
    v_exp_f32 v114, v82
    v_exp_f32 v115, v83
    v_mfma_f32_32x32x16_bf16 v[64:79], v[132:135], v[20:23], v[64:79]
    ds_read_b128 v[140:143], v177 offset:13312
    v_exp_f32 v116, v84
    v_exp_f32 v117, v85
    v_exp_f32 v118, v86
    v_exp_f32 v119, v87
    v_smfmac_f32_32x32x32_bf16 v[208:223], v[152:155], v[96:103], v176
    ds_read_b128 v[168:171], v177 offset:14336
    v_exp_f32 v120, v88
    v_exp_f32 v121, v89
    v_exp_f32 v122, v90
    v_exp_f32 v123, v91
    v_smfmac_f32_32x32x32_bf16 v[208:223], v[156:159], v[104:111], v176
    ds_read_b128 v[172:175], v177 offset:15360
    v_exp_f32 v124, v92
    v_exp_f32 v125, v93
    v_exp_f32 v126, v94
    v_exp_f32 v127, v95
    v_mfma_f32_32x32x16_bf16 v[80:95], v[128:131], v[24:27], 0
    v_exp_f32 v96, v64
    v_exp_f32 v97, v65
    v_exp_f32 v98, v66
    v_exp_f32 v99, v67
    v_mfma_f32_32x32x16_bf16 v[80:95], v[132:135], v[28:31], v[80:95]
    v_exp_f32 v100, v68
    v_exp_f32 v101, v69
    v_exp_f32 v102, v70
    v_exp_f32 v103, v71
    v_smfmac_f32_32x32x32_bf16 v[224:239], v[152:155], v[112:119], v176
    v_exp_f32 v104, v72
    v_exp_f32 v105, v73
    v_exp_f32 v106, v74
    v_exp_f32 v107, v75
    v_smfmac_f32_32x32x32_bf16 v[224:239], v[156:159], v[120:127], v176
    v_exp_f32_e64 v108, v76
    v_exp_f32 v109, v77
    v_exp_f32 v110, v78
    v_exp_f32 v111, v79
    s_waitcnt lgkmcnt(0)
    v_mfma_f32_32x32x16_bf16 v[64:79], v[136:139], v[16:19], 0
    ds_write_b32 v242, v13 offset:368
    v_exp_f32 v112, v80
    v_exp_f32 v113, v81
    v_exp_f32 v114, v82
    v_exp_f32 v115, v83
    v_mfma_f32_32x32x16_bf16 v[64:79], v[140:143], v[20:23], v[64:79]
    v_exp_f32 v116, v84
    v_exp_f32 v117, v85
    v_exp_f32 v118, v86
    v_exp_f32 v119, v87
    v_smfmac_f32_32x32x32_bf16 v[208:223], v[160:163], v[96:103], v176
    v_exp_f32 v120, v88
    v_exp_f32 v121, v89
    v_exp_f32 v122, v90
    v_exp_f32 v123, v91
    v_smfmac_f32_32x32x32_bf16 v[208:223], v[164:167], v[104:111], v176
    v_exp_f32 v124, v92
    v_exp_f32 v125, v93
    v_exp_f32 v126, v94
    v_exp_f32 v127, v95
    v_mfma_f32_32x32x16_bf16 v[80:95], v[136:139], v[24:27], 0
    v_exp_f32 v96, v64
    v_exp_f32 v97, v65
    v_exp_f32 v98, v66
    v_exp_f32 v99, v67
    v_mfma_f32_32x32x16_bf16 v[80:95], v[140:143], v[28:31], v[80:95]
    v_exp_f32 v100, v68
    v_exp_f32 v101, v69
    v_exp_f32 v102, v70
    v_exp_f32 v103, v71
    v_smfmac_f32_32x32x32_bf16 v[224:239], v[160:163], v[112:119], v176
    v_exp_f32 v104, v72
    v_exp_f32 v105, v73
    v_exp_f32 v106, v74
    v_exp_f32 v107, v75
    v_smfmac_f32_32x32x32_bf16 v[224:239], v[164:167], v[120:127], v176
    v_exp_f32 v108, v76
    v_exp_f32 v109, v77
    v_exp_f32 v110, v78
    v_exp_f32 v111, v79
    v_exp_f32 v112, v80
    v_exp_f32 v113, v81
    v_smfmac_f32_32x32x32_bf16 v[208:223], v[168:171], v[96:103], v176
    ds_read_b32 v243, v241 offset:368
    v_exp_f32 v114, v82
    v_exp_f32 v115, v83
    v_exp_f32 v116, v84
    v_exp_f32 v117, v85
    v_smfmac_f32_32x32x32_bf16 v[208:223], v[172:175], v[104:111], v176
    v_exp_f32 v118, v86
    v_exp_f32 v119, v87
    v_exp_f32 v120, v88
    v_exp_f32 v121, v89
    v_smfmac_f32_32x32x32_bf16 v[224:239], v[168:171], v[112:119], v176
    v_exp_f32 v122, v90
    v_exp_f32 v123, v91
    v_exp_f32 v124, v92
    v_exp_f32 v125, v93
    v_exp_f32 v126, v94
    v_exp_f32 v127, v95
    s_setprio 3
    s_waitcnt lgkmcnt(0)
    v_smfmac_f32_32x32x32_bf16 v[224:239], v[172:175], v[120:127], v176
    v_cmp_ne_u32 vcc, 1, v243
    v_xor_b32 v5, 8, v242
    s_cbranch_vccnz L_slow_c7
L_back_c7:
    s_nop 0
    ds_write_b128 v178, v[208:211] offset:0
    ds_write_b128 v178, v[212:215] offset:1024
    ds_write_b128 v178, v[216:219] offset:2048
    ds_write_b128 v178, v[220:223] offset:3072
    ds_write_b32 v242, v13 offset:16
    s_mov_b32 s82, 1048576
L_xch:
    ds_read_b32 v4, v5 offset:16
    ds_read_b128 v[64:67], v179 offset:0
    ds_read_b128 v[68:71], v179 offset:1024
    ds_read_b128 v[72:75], v179 offset:2048
    ds_read_b128 v[76:79], v179 offset:3072
    s_sub_u32 s82, s82, 1
    s_cmp_eq_u32 s82, 0
    s_cbranch_scc1 L_xchx
    s_waitcnt lgkmcnt(4)
    v_cmp_ne_u32 vcc, 1, v4
    s_nop 0
    s_cbranch_vccnz L_xch
L_xchx:
    s_waitcnt lgkmcnt(3)
    v_pk_add_f32 v[224:225], v[224:225], v[64:65]
    v_pk_add_f32 v[226:227], v[226:227], v[66:67]
    s_waitcnt lgkmcnt(2)
    v_pk_add_f32 v[228:229], v[228:229], v[68:69]
    v_pk_add_f32 v[230:231], v[230:231], v[70:71]
    s_waitcnt lgkmcnt(1)
    v_pk_add_f32 v[232:233], v[232:233], v[72:73]
    v_pk_add_f32 v[234:235], v[234:235], v[74:75]
    s_waitcnt lgkmcnt(0)
    v_pk_add_f32 v[236:237], v[236:237], v[76:77]
    v_pk_add_f32 v[238:239], v[238:239], v[78:79]
    s_mov_b32 s65, 0x7b800000
    s_mov_b32 s64, 0x07800000
    s_mov_b32 s66, 0x72000000
L_final:
    v_rcp_f32 v6, v236
    v_rcp_f32 v8, v236
    s_nop 1
    v_permlane32_swap_b32 v8, v6
    v_pk_mul_f32 v[96:97], v[224:225], v[6:7] op_sel_hi:[1,0]
    v_pk_mul_f32 v[98:99], v[226:227], v[6:7] op_sel_hi:[1,0]
    v_pk_mul_f32 v[100:101], v[228:229], v[6:7] op_sel_hi:[1,0]
    v_pk_mul_f32 v[102:103], v[230:231], v[6:7] op_sel_hi:[1,0]
    v_pk_mul_f32 v[104:105], v[232:233], v[6:7] op_sel_hi:[1,0]
    v_pk_mul_f32 v[106:107], v[234:235], v[6:7] op_sel_hi:[1,0]
    v_pk_mul_f32 v[108:109], v[236:237], v[6:7] op_sel_hi:[1,0]
    v_pk_mul_f32 v[110:111], v[238:239], v[6:7] op_sel_hi:[1,0]
    v_cvt_pk_bf16_f32 v48, v96, v97
    v_cvt_pk_bf16_f32 v49, v98, v99
    v_cvt_pk_bf16_f32 v50, v100, v101
    v_cvt_pk_bf16_f32 v51, v102, v103
    buffer_store_dwordx4 v[48:51], v14, s[32:35], s30 offen sc1
    v_cvt_pk_bf16_f32 v52, v104, v105
    v_cvt_pk_bf16_f32 v53, v106, v107
    v_cvt_pk_bf16_f32 v54, v108, v109
    v_cvt_pk_bf16_f32 v55, v110, v111
    s_mov_b64 exec, s[86:87]
    v_mov_b32 v54, 0
    s_mov_b64 exec, -1
    buffer_store_dwordx4 v[52:55], v14, s[32:35], s30 offen offset:512 sc1
    ds_write_b32 v242, v13 offset:64
    ds_read_b32 v243, v241 offset:192
    v_add_f32_e64 v4, abs(v224), abs(v225)
    v_add_f32_e64 v5, abs(v226), abs(v227)
    v_add_f32_e64 v4, v4, abs(v228)
    v_add_f32_e64 v5, v5, abs(v229)
    v_add_f32_e64 v4, v4, abs(v230)
    v_add_f32_e64 v5, v5, abs(v231)
    v_add_f32_e64 v4, v4, abs(v232)
    v_add_f32_e64 v5, v5, abs(v233)
    v_add_f32_e64 v4, v4, abs(v234)
    v_add_f32_e64 v5, v5, abs(v235)
    v_add_f32_e64 v4, v4, abs(v236)
    v_add_f32_e64 v5, v5, abs(v237)
    v_add_f32_e64 v4, v4, abs(v238)
    v_add_f32_e64 v5, v5, abs(v239)
    v_add_f32 v4, v4, v5
    v_cmp_ngt_f32 vcc, s65, v4
    v_cmp_gt_f32 s[62:63], s64, v4
    v_cmp_lt_f32 s[60:61], s66, v6
    s_or_b64 vcc, vcc, s[62:63]
    s_or_b64 vcc, vcc, s[60:61]
    s_cbranch_scc1 L_fallback
    s_cmp_eq_u32 s70, -1
    s_cbranch_scc1 L_drain
L_safe:
    s_mov_b64 exec, 1
    buffer_atomic_add v47, v1, s[32:35], s31 offen sc1
    s_mov_b64 exec, -1
    s_cmp_ge_u32 s54, 28
    s_cbranch_scc1 L_fin
    s_waitcnt lgkmcnt(0)
    v_cmp_ne_u32 vcc, 1, v243
    s_mov_b32 s70, 4096
    s_cbranch_vccnz L_slow_r8
L_back_r8:
    s_nop 0
L_again:
    ds_read_b64_tr_b16 v[112:113], v32 offset:0
    ds_read_b64_tr_b16 v[114:115], v36 offset:1024
    ds_read_b64_tr_b16 v[116:117], v33 offset:0
    ds_read_b64_tr_b16 v[118:119], v37 offset:1024
    ds_read_b64_tr_b16 v[120:121], v34 offset:0
    ds_read_b64_tr_b16 v[122:123], v38 offset:1024
    ds_read_b64_tr_b16 v[124:125], v35 offset:0
    ds_read_b64_tr_b16 v[126:127], v39 offset:1024
    ds_read_b64_tr_b16 v[128:129], v34 offset:3584
    ds_read_b64_tr_b16 v[130:131], v38 offset:4608
    ds_read_b64_tr_b16 v[132:133], v35 offset:3584
    ds_read_b64_tr_b16 v[134:135], v39 offset:4608
    ds_read_b64_tr_b16 v[136:137], v32 offset:3584
    ds_read_b64_tr_b16 v[138:139], v36 offset:4608
    ds_read_b64_tr_b16 v[140:141], v33 offset:3584
    ds_read_b64_tr_b16 v[142:143], v37 offset:4608
    ds_read_b64_tr_b16 v[144:145], v32 offset:14336
    ds_read_b64_tr_b16 v[146:147], v36 offset:15360
    ds_read_b64_tr_b16 v[148:149], v33 offset:14336
    ds_read_b64_tr_b16 v[150:151], v37 offset:15360
    ds_read_b64_tr_b16 v[152:153], v34 offset:14336
    ds_read_b64_tr_b16 v[154:155], v38 offset:15360
    ds_read_b64_tr_b16 v[156:157], v35 offset:14336
    ds_read_b64_tr_b16 v[158:159], v39 offset:15360
    ds_read_b64_tr_b16 v[160:161], v34 offset:17920
    ds_read_b64_tr_b16 v[162:163], v38 offset:18944
    ds_read_b64_tr_b16 v[164:165], v35 offset:17920
    ds_read_b64_tr_b16 v[166:167], v39 offset:18944
    ds_read_b64_tr_b16 v[168:169], v32 offset:17920
    ds_read_b64_tr_b16 v[170:171], v36 offset:18944
    ds_read_b64_tr_b16 v[172:173], v33 offset:17920
    ds_read_b64_tr_b16 v[174:175], v37 offset:18944
    ds_read_b64_tr_b16 v[176:177], v32 offset:28672
    ds_read_b64_tr_b16 v[178:179], v36 offset:29696
    ds_read_b64_tr_b16 v[180:181], v33 offset:28672
    ds_read_b64_tr_b16 v[182:183], v37 offset:29696
    ds_read_b64_tr_b16 v[184:185], v34 offset:28672
    ds_read_b64_tr_b16 v[186:187], v38 offset:29696
    ds_read_b64_tr_b16 v[188:189], v35 offset:28672
    ds_read_b64_tr_b16 v[190:191], v39 offset:29696
    ds_read_b64_tr_b16 v[192:193], v34 offset:32256
    ds_read_b64_tr_b16 v[194:195], v38 offset:33280
    ds_read_b64_tr_b16 v[196:197], v35 offset:32256
    ds_read_b64_tr_b16 v[198:199], v39 offset:33280
    ds_read_b64_tr_b16 v[200:201], v32 offset:32256
    ds_read_b64_tr_b16 v[202:203], v36 offset:33280
    ds_read_b64_tr_b16 v[204:205], v33 offset:32256
    ds_read_b64_tr_b16 v[206:207], v37 offset:33280
    ds_read_b64_tr_b16 v[208:209], v32 offset:43008
    ds_read_b64_tr_b16 v[210:211], v36 offset:44032
    ds_read_b64_tr_b16 v[212:213], v33 offset:43008
    ds_read_b64_tr_b16 v[214:215], v37 offset:44032
    ds_read_b64_tr_b16 v[216:217], v34 offset:43008
    ds_read_b64_tr_b16 v[218:219], v38 offset:44032
    ds_read_b64_tr_b16 v[220:221], v35 offset:43008
    ds_read_b64_tr_b16 v[222:223], v39 offset:44032
    ds_read_b64_tr_b16 v[224:225], v34 offset:46592
    ds_read_b64_tr_b16 v[226:227], v38 offset:47616
    ds_read_b64_tr_b16 v[228:229], v35 offset:46592
    ds_read_b64_tr_b16 v[230:231], v39 offset:47616
    ds_read_b64_tr_b16 v[232:233], v32 offset:46592
    ds_read_b64_tr_b16 v[234:235], v36 offset:47616
    ds_read_b64_tr_b16 v[236:237], v33 offset:46592
    ds_read_b64_tr_b16 v[238:239], v37 offset:47616
    s_mov_b64 exec, 1
    s_mov_b32 s82, 65536
L_poll_s3:
    v_mov_b32 v240, 0
    s_sub_u32 s82, s82, 1
    buffer_atomic_add v240, v1, s[32:35], s24 offen sc0 sc1
    s_cmp_eq_u32 s82, 0
    s_waitcnt vmcnt(0)
    v_readfirstlane_b32 s60, v240
    v_and_b32 v240, 15, v240
    v_cmp_ne_u32 vcc, 8, v240
    s_cbranch_scc1 L_pollx_s3
    s_cbranch_vccnz L_poll_s3
L_pollx_s3:
    s_mov_b64 exec, -1
    buffer_load_dwordx4 v[48:51], v2, s[32:35], s25 offen offset:0 sc1
    buffer_load_dwordx4 v[52:55], v2, s[32:35], s25 offen offset:2048 sc1
    s_add_u32 s25, s25, 4096
    buffer_load_dwordx4 v[56:59], v2, s[32:35], s25 offen offset:0 sc1
    buffer_load_dwordx4 v[60:63], v2, s[32:35], s25 offen offset:2048 sc1
    s_add_u32 s25, s25, 4096
    buffer_load_dwordx4 v[64:67], v2, s[32:35], s25 offen offset:0 sc1
    buffer_load_dwordx4 v[68:71], v2, s[32:35], s25 offen offset:2048 sc1
    s_add_u32 s25, s25, 4096
    buffer_load_dwordx4 v[72:75], v2, s[32:35], s25 offen offset:0 sc1
    buffer_load_dwordx4 v[76:79], v2, s[32:35], s25 offen offset:2048 sc1
    s_cmp_lg_u32 s60, 0x88
    s_cbranch_scc0 L_g_two
    s_mov_b64 exec, 1
    s_mov_b32 s82, 65536
L_poll_s3h:
    v_mov_b32 v240, 0
    s_sub_u32 s82, s82, 1
    buffer_atomic_add v240, v1, s[32:35], s24 offen sc0 sc1
    s_cmp_eq_u32 s82, 0
    s_waitcnt vmcnt(0)
    v_cmp_ne_u32 vcc, 136, v240
    s_cbranch_scc1 L_pollx_s3h
    s_cbranch_vccnz L_poll_s3h
L_pollx_s3h:
    s_mov_b64 exec, -1
L_g_two:
    buffer_load_dwordx4 v[80:83], v2, s[32:35], s26 offen offset:0 sc1
    buffer_load_dwordx4 v[84:87], v2, s[32:35], s26 offen offset:2048 sc1
    s_add_u32 s26, s26, 4096
    buffer_load_dwordx4 v[88:91], v2, s[32:35], s26 offen offset:0 sc1
    buffer_load_dwordx4 v[92:95], v2, s[32:35], s26 offen offset:2048 sc1
    s_add_u32 s26, s26, 4096
    buffer_load_dwordx4 v[96:99], v2, s[32:35], s26 offen offset:0 sc1
    buffer_load_dwordx4 v[100:103], v2, s[32:35], s26 offen offset:2048 sc1
    s_add_u32 s26, s26, 4096
    buffer_load_dwordx4 v[104:107], v2, s[32:35], s26 offen offset:0 sc1
    buffer_load_dwordx4 v[108:111], v2, s[32:35], s26 offen offset:2048 sc1
.p2align 3
L_p3:
    s_waitcnt vmcnt(15) lgkmcnt(0)
    s_nop 0
    v_mfma_f32_16x16x32_bf16 v[16:19], v[112:115], v[48:51], 0
    ds_read_b64_tr_b16 v[112:113], v32 offset:7168
    ds_read_b64_tr_b16 v[114:115], v36 offset:8192
    v_mfma_f32_16x16x32_bf16 v[20:23], v[116:119], v[48:51], 0
    ds_read_b64_tr_b16 v[116:117], v33 offset:7168
    ds_read_b64_tr_b16 v[118:119], v37 offset:8192
    v_mfma_f32_16x16x32_bf16 v[24:27], v[120:123], v[48:51], 0
    ds_read_b64_tr_b16 v[120:121], v34 offset:7168
    ds_read_b64_tr_b16 v[122:123], v38 offset:8192
    v_mfma_f32_16x16x32_bf16 v[28:31], v[124:127], v[48:51], 0
    ds_read_b64_tr_b16 v[124:125], v35 offset:7168
    ds_read_b64_tr_b16 v[126:127], v39 offset:8192
    s_waitcnt vmcnt(14)
    s_nop 0
    v_mfma_f32_16x16x32_bf16 v[16:19], v[128:131], v[52:55], v[16:19]
    ds_read_b64_tr_b16 v[128:129], v34 offset:10752
    ds_read_b64_tr_b16 v[130:131], v38 offset:11776
    v_mfma_f32_16x16x32_bf16 v[20:23], v[132:135], v[52:55], v[20:23]
    ds_read_b64_tr_b16 v[132:133], v35 offset:10752
    ds_read_b64_tr_b16 v[134:135], v39 offset:11776
    v_mfma_f32_16x16x32_bf16 v[24:27], v[136:139], v[52:55], v[24:27]
    ds_read_b64_tr_b16 v[136:137], v32 offset:10752
    ds_read_b64_tr_b16 v[138:139], v36 offset:11776
    v_mfma_f32_16x16x32_bf16 v[28:31], v[140:143], v[52:55], v[28:31]
    ds_read_b64_tr_b16 v[140:141], v33 offset:10752
    ds_read_b64_tr_b16 v[142:143], v37 offset:11776
    s_waitcnt vmcnt(13)
    s_nop 0
    v_mfma_f32_16x16x32_bf16 v[16:19], v[144:147], v[56:59], v[16:19]
    ds_read_b64_tr_b16 v[144:145], v32 offset:21504
    ds_read_b64_tr_b16 v[146:147], v36 offset:22528
    v_mfma_f32_16x16x32_bf16 v[20:23], v[148:151], v[56:59], v[20:23]
    ds_read_b64_tr_b16 v[148:149], v33 offset:21504
    ds_read_b64_tr_b16 v[150:151], v37 offset:22528
    v_mfma_f32_16x16x32_bf16 v[24:27], v[152:155], v[56:59], v[24:27]
    ds_read_b64_tr_b16 v[152:153], v34 offset:21504
    ds_read_b64_tr_b16 v[154:155], v38 offset:22528
    v_mfma_f32_16x16x32_bf16 v[28:31], v[156:159], v[56:59], v[28:31]
    ds_read_b64_tr_b16 v[156:157], v35 offset:21504
    ds_read_b64_tr_b16 v[158:159], v39 offset:22528
    s_waitcnt vmcnt(12)
    s_nop 0
    v_mfma_f32_16x16x32_bf16 v[16:19], v[160:163], v[60:63], v[16:19]
    ds_read_b64_tr_b16 v[160:161], v34 offset:25088
    ds_read_b64_tr_b16 v[162:163], v38 offset:26112
    v_mfma_f32_16x16x32_bf16 v[20:23], v[164:167], v[60:63], v[20:23]
    ds_read_b64_tr_b16 v[164:165], v35 offset:25088
    ds_read_b64_tr_b16 v[166:167], v39 offset:26112
    v_mfma_f32_16x16x32_bf16 v[24:27], v[168:171], v[60:63], v[24:27]
    ds_read_b64_tr_b16 v[168:169], v32 offset:25088
    ds_read_b64_tr_b16 v[170:171], v36 offset:26112
    v_mfma_f32_16x16x32_bf16 v[28:31], v[172:175], v[60:63], v[28:31]
    ds_read_b64_tr_b16 v[172:173], v33 offset:25088
    ds_read_b64_tr_b16 v[174:175], v37 offset:26112
    s_waitcnt vmcnt(11)
    s_nop 0
    v_mfma_f32_16x16x32_bf16 v[16:19], v[176:179], v[64:67], v[16:19]
    ds_read_b64_tr_b16 v[176:177], v32 offset:35840
    ds_read_b64_tr_b16 v[178:179], v36 offset:36864
    v_mfma_f32_16x16x32_bf16 v[20:23], v[180:183], v[64:67], v[20:23]
    ds_read_b64_tr_b16 v[180:181], v33 offset:35840
    ds_read_b64_tr_b16 v[182:183], v37 offset:36864
    v_mfma_f32_16x16x32_bf16 v[24:27], v[184:187], v[64:67], v[24:27]
    ds_read_b64_tr_b16 v[184:185], v34 offset:35840
    ds_read_b64_tr_b16 v[186:187], v38 offset:36864
    v_mfma_f32_16x16x32_bf16 v[28:31], v[188:191], v[64:67], v[28:31]
    ds_read_b64_tr_b16 v[188:189], v35 offset:35840
    ds_read_b64_tr_b16 v[190:191], v39 offset:36864
    s_waitcnt vmcnt(10)
    s_nop 0
    v_mfma_f32_16x16x32_bf16 v[16:19], v[192:195], v[68:71], v[16:19]
    ds_read_b64_tr_b16 v[192:193], v34 offset:39424
    ds_read_b64_tr_b16 v[194:195], v38 offset:40448
    v_mfma_f32_16x16x32_bf16 v[20:23], v[196:199], v[68:71], v[20:23]
    ds_read_b64_tr_b16 v[196:197], v35 offset:39424
    ds_read_b64_tr_b16 v[198:199], v39 offset:40448
    v_mfma_f32_16x16x32_bf16 v[24:27], v[200:203], v[68:71], v[24:27]
    ds_read_b64_tr_b16 v[200:201], v32 offset:39424
    ds_read_b64_tr_b16 v[202:203], v36 offset:40448
    v_mfma_f32_16x16x32_bf16 v[28:31], v[204:207], v[68:71], v[28:31]
    ds_read_b64_tr_b16 v[204:205], v33 offset:39424
    ds_read_b64_tr_b16 v[206:207], v37 offset:40448
    s_waitcnt vmcnt(9)
    s_nop 0
    v_mfma_f32_16x16x32_bf16 v[16:19], v[208:211], v[72:75], v[16:19]
    ds_read_b64_tr_b16 v[208:209], v32 offset:50176
    ds_read_b64_tr_b16 v[210:211], v36 offset:51200
    v_mfma_f32_16x16x32_bf16 v[20:23], v[212:215], v[72:75], v[20:23]
    ds_read_b64_tr_b16 v[212:213], v33 offset:50176
    ds_read_b64_tr_b16 v[214:215], v37 offset:51200
    v_mfma_f32_16x16x32_bf16 v[24:27], v[216:219], v[72:75], v[24:27]
    ds_read_b64_tr_b16 v[216:217], v34 offset:50176
    ds_read_b64_tr_b16 v[218:219], v38 offset:51200
    v_mfma_f32_16x16x32_bf16 v[28:31], v[220:223], v[72:75], v[28:31]
    ds_read_b64_tr_b16 v[220:221], v35 offset:50176
    ds_read_b64_tr_b16 v[222:223], v39 offset:51200
    s_waitcnt vmcnt(8)
    s_nop 0
    v_mfma_f32_16x16x32_bf16 v[16:19], v[224:227], v[76:79], v[16:19]
    ds_read_b64_tr_b16 v[224:225], v34 offset:53760
    ds_read_b64_tr_b16 v[226:227], v38 offset:54784
    v_mfma_f32_16x16x32_bf16 v[20:23], v[228:231], v[76:79], v[20:23]
    ds_read_b64_tr_b16 v[228:229], v35 offset:53760
    ds_read_b64_tr_b16 v[230:231], v39 offset:54784
    v_mfma_f32_16x16x32_bf16 v[24:27], v[232:235], v[76:79], v[24:27]
    ds_read_b64_tr_b16 v[232:233], v32 offset:53760
    ds_read_b64_tr_b16 v[234:235], v36 offset:54784
    v_mfma_f32_16x16x32_bf16 v[28:31], v[236:239], v[76:79], v[28:31]
    ds_read_b64_tr_b16 v[236:237], v33 offset:53760
    ds_read_b64_tr_b16 v[238:239], v37 offset:54784
    s_waitcnt vmcnt(7) lgkmcnt(14)
    s_nop 0
    v_mfma_f32_16x16x32_bf16 v[16:19], v[112:115], v[80:83], v[16:19]
    v_max3_u32 v46, 0, v80, v81
    v_mfma_f32_16x16x32_bf16 v[20:23], v[116:119], v[80:83], v[20:23]
    v_max3_u32 v46, v46, v82, v83
    v_mfma_f32_16x16x32_bf16 v[24:27], v[120:123], v[80:83], v[24:27]
    v_max3_u32 v46, v46, v48, v49
    v_mfma_f32_16x16x32_bf16 v[28:31], v[124:127], v[80:83], v[28:31]
    v_max3_u32 v46, v46, v50, v51
    s_waitcnt vmcnt(6)
    s_nop 0
    v_mfma_f32_16x16x32_bf16 v[16:19], v[128:131], v[84:87], v[16:19]
    v_max3_u32 v46, v46, v84, v85
    v_mfma_f32_16x16x32_bf16 v[20:23], v[132:135], v[84:87], v[20:23]
    v_max3_u32 v46, v46, v86, v87
    v_mfma_f32_16x16x32_bf16 v[24:27], v[136:139], v[84:87], v[24:27]
    v_max3_u32 v46, v46, v52, v53
    v_mfma_f32_16x16x32_bf16 v[28:31], v[140:143], v[84:87], v[28:31]
    v_max3_u32 v46, v46, v54, v55
    s_waitcnt vmcnt(5)
    s_nop 0
    v_mfma_f32_16x16x32_bf16 v[16:19], v[144:147], v[88:91], v[16:19]
    v_max3_u32 v46, v46, v88, v89
    v_mfma_f32_16x16x32_bf16 v[20:23], v[148:151], v[88:91], v[20:23]
    v_max3_u32 v46, v46, v90, v91
    v_mfma_f32_16x16x32_bf16 v[24:27], v[152:155], v[88:91], v[24:27]
    v_max3_u32 v46, v46, v56, v57
    v_mfma_f32_16x16x32_bf16 v[28:31], v[156:159], v[88:91], v[28:31]
    v_max3_u32 v46, v46, v58, v59
    s_waitcnt vmcnt(4)
    s_nop 0
    v_mfma_f32_16x16x32_bf16 v[16:19], v[160:163], v[92:95], v[16:19]
    v_max3_u32 v46, v46, v92, v93
    v_mfma_f32_16x16x32_bf16 v[20:23], v[164:167], v[92:95], v[20:23]
    v_max3_u32 v46, v46, v94, v95
    v_mfma_f32_16x16x32_bf16 v[24:27], v[168:171], v[92:95], v[24:27]
    v_max3_u32 v46, v46, v60, v61
    v_mfma_f32_16x16x32_bf16 v[28:31], v[172:175], v[92:95], v[28:31]
    v_max3_u32 v46, v46, v62, v63
    s_waitcnt vmcnt(3)
    s_nop 0
    v_mfma_f32_16x16x32_bf16 v[16:19], v[176:179], v[96:99], v[16:19]
    v_max3_u32 v46, v46, v96, v97
    v_mfma_f32_16x16x32_bf16 v[20:23], v[180:183], v[96:99], v[20:23]
    v_max3_u32 v46, v46, v98, v99
    v_mfma_f32_16x16x32_bf16 v[24:27], v[184:187], v[96:99], v[24:27]
    v_max3_u32 v46, v46, v64, v65
    v_mfma_f32_16x16x32_bf16 v[28:31], v[188:191], v[96:99], v[28:31]
    v_max3_u32 v46, v46, v66, v67
    s_waitcnt vmcnt(2)
    s_nop 0
    v_mfma_f32_16x16x32_bf16 v[16:19], v[192:195], v[100:103], v[16:19]
    v_max3_u32 v46, v46, v100, v101
    v_mfma_f32_16x16x32_bf16 v[20:23], v[196:199], v[100:103], v[20:23]
    v_max3_u32 v46, v46, v102, v103
    v_mfma_f32_16x16x32_bf16 v[24:27], v[200:203], v[100:103], v[24:27]
    v_max3_u32 v46, v46, v68, v69
    v_mfma_f32_16x16x32_bf16 v[28:31], v[204:207], v[100:103], v[28:31]
    v_max3_u32 v46, v46, v70, v71
    s_waitcnt vmcnt(1) lgkmcnt(8)
    s_nop 0
    v_mfma_f32_16x16x32_bf16 v[16:19], v[208:211], v[104:107], v[16:19]
    v_max3_u32 v46, v46, v104, v105
    v_mfma_f32_16x16x32_bf16 v[20:23], v[212:215], v[104:107], v[20:23]
    v_max3_u32 v46, v46, v106, v107
    v_mfma_f32_16x16x32_bf16 v[24:27], v[216:219], v[104:107], v[24:27]
    v_max3_u32 v46, v46, v72, v73
    v_mfma_f32_16x16x32_bf16 v[28:31], v[220:223], v[104:107], v[28:31]
    v_max3_u32 v46, v46, v74, v75
    s_waitcnt vmcnt(0) lgkmcnt(0)
    s_nop 0
    v_mfma_f32_16x16x32_bf16 v[16:19], v[224:227], v[108:111], v[16:19]
    v_max3_u32 v46, v46, v108, v109
    v_mfma_f32_16x16x32_bf16 v[20:23], v[228:231], v[108:111], v[20:23]
    v_max3_u32 v46, v46, v110, v111
    v_mfma_f32_16x16x32_bf16 v[24:27], v[232:235], v[108:111], v[24:27]
    v_max3_u32 v46, v46, v76, v77
    v_mfma_f32_16x16x32_bf16 v[28:31], v[236:239], v[108:111], v[28:31]
    v_max3_u32 v46, v46, v78, v79
    v_cmp_eq_u32 vcc, -1, v46
    s_nop 0
    s_cbranch_vccnz L_retry
L_good:
    v_cvt_pk_bf16_f32 v48, v16, v17
    v_cvt_pk_bf16_f32 v49, v18, v19
    ds_write_b64 v40, v[48:49]
    v_cvt_pk_bf16_f32 v50, v20, v21
    v_cvt_pk_bf16_f32 v51, v22, v23
    ds_write_b64 v41, v[50:51]
    v_cvt_pk_bf16_f32 v52, v24, v25
    v_cvt_pk_bf16_f32 v53, v26, v27
    ds_write_b64 v42, v[52:53]
    v_cvt_pk_bf16_f32 v54, v28, v29
    v_cvt_pk_bf16_f32 v55, v30, v31
    ds_write_b64 v43, v[54:55]
    ds_read_b128 v[56:59], v44
    ds_read_b128 v[60:63], v44 offset:1024
    s_waitcnt lgkmcnt(1)
    buffer_store_dwordx4 v[56:59], v45, s[48:51], s28 offen sc1
    s_waitcnt lgkmcnt(0)
    buffer_store_dwordx4 v[60:63], v45, s[48:51], s29 offen sc1
L_fin:
    s_endpgm
L_retry:
    s_cmp_eq_u32 s81, 1
    s_cbranch_scc1 L_good
    s_sub_u32 s70, s70, 1
    s_cbranch_scc1 L_good
    s_sub_u32 s25, s25, 12288
    s_sub_u32 s26, s26, 12288
    s_branch L_again
L_drain:
    s_waitcnt vmcnt(0)
    s_branch L_safe
L_slow_r0:
    s_mov_b32 s82, 1048576
L_lw_sr0:
    ds_read_b32 v243, v241 offset:48
    s_sub_u32 s82, s82, 1
    s_waitcnt lgkmcnt(0)
    v_cmp_ne_u32 vcc, 1, v243
    s_cmp_eq_u32 s82, 0
    s_cbranch_scc1 L_lwx_sr0
    s_cbranch_vccnz L_lw_sr0
L_lwx_sr0:
    s_branch L_back_r0
L_slow_r1:
    s_mov_b32 s82, 1048576
L_lw_sr1:
    ds_read_b32 v243, v241 offset:80
    s_sub_u32 s82, s82, 1
    s_waitcnt lgkmcnt(0)
    v_cmp_ne_u32 vcc, 1, v243
    s_cmp_eq_u32 s82, 0
    s_cbranch_scc1 L_lwx_sr1
    s_cbranch_vccnz L_lw_sr1
L_lwx_sr1:
    s_branch L_back_r1
L_slow_r2:
    s_mov_b32 s82, 1048576
L_lw_sr2:
    ds_read_b32 v243, v241 offset:96
    s_sub_u32 s82, s82, 1
    s_waitcnt lgkmcnt(0)
    v_cmp_ne_u32 vcc, 1, v243
    s_cmp_eq_u32 s82, 0
    s_cbranch_scc1 L_lwx_sr2
    s_cbranch_vccnz L_lw_sr2
L_lwx_sr2:
    s_branch L_back_r2
L_slow_r3:
    s_mov_b32 s82, 1048576
L_lw_sr3:
    ds_read_b32 v243, v241 offset:112
    s_sub_u32 s82, s82, 1
    s_waitcnt lgkmcnt(0)
    v_cmp_ne_u32 vcc, 1, v243
    s_cmp_eq_u32 s82, 0
    s_cbranch_scc1 L_lwx_sr3
    s_cbranch_vccnz L_lw_sr3
L_lwx_sr3:
    s_branch L_back_r3
L_slow_r4:
    s_mov_b32 s82, 1048576
L_lw_sr4:
    ds_read_b32 v243, v241 offset:128
    s_sub_u32 s82, s82, 1
    s_waitcnt lgkmcnt(0)
    v_cmp_ne_u32 vcc, 1, v243
    s_cmp_eq_u32 s82, 0
    s_cbranch_scc1 L_lwx_sr4
    s_cbranch_vccnz L_lw_sr4
L_lwx_sr4:
    s_branch L_back_r4
L_slow_r5:
    s_mov_b32 s82, 1048576
L_lw_sr5:
    ds_read_b32 v243, v241 offset:144
    s_sub_u32 s82, s82, 1
    s_waitcnt lgkmcnt(0)
    v_cmp_ne_u32 vcc, 1, v243
    s_cmp_eq_u32 s82, 0
    s_cbranch_scc1 L_lwx_sr5
    s_cbranch_vccnz L_lw_sr5
L_lwx_sr5:
    s_branch L_back_r5
L_slow_r6:
    s_mov_b32 s82, 1048576
L_lw_sr6:
    ds_read_b32 v243, v241 offset:160
    s_sub_u32 s82, s82, 1
    s_waitcnt lgkmcnt(0)
    v_cmp_ne_u32 vcc, 1, v243
    s_cmp_eq_u32 s82, 0
    s_cbranch_scc1 L_lwx_sr6
    s_cbranch_vccnz L_lw_sr6
L_lwx_sr6:
    s_branch L_back_r6
L_slow_r7:
    s_mov_b32 s82, 1048576
L_lw_sr7:
    ds_read_b32 v243, v241 offset:176
    s_sub_u32 s82, s82, 1
    s_waitcnt lgkmcnt(0)
    v_cmp_ne_u32 vcc, 1, v243
    s_cmp_eq_u32 s82, 0
    s_cbranch_scc1 L_lwx_sr7
    s_cbranch_vccnz L_lw_sr7
L_lwx_sr7:
    s_branch L_back_r7
L_slow_c7:
    s_mov_b32 s82, 1048576
L_lw_sc7:
    ds_read_b32 v243, v241 offset:368
    s_sub_u32 s82, s82, 1
    s_waitcnt lgkmcnt(0)
    v_cmp_ne_u32 vcc, 1, v243
    s_cmp_eq_u32 s82, 0
    s_cbranch_scc1 L_lwx_sc7
    s_cbranch_vccnz L_lw_sc7
L_lwx_sc7:
    s_branch L_back_c7
L_slow_r8:
    s_mov_b32 s82, 1048576
L_lw_sr8:
    ds_read_b32 v243, v241 offset:192
    s_sub_u32 s82, s82, 1
    s_waitcnt lgkmcnt(0)
    v_cmp_ne_u32 vcc, 1, v243
    s_cmp_eq_u32 s82, 0
    s_cbranch_scc1 L_lwx_sr8
    s_cbranch_vccnz L_lw_sr8
L_lwx_sr8:
    s_branch L_back_r8
L_fallback:
    s_cmp_eq_u32 s70, -1
    s_cbranch_scc1 L_drain
    s_mov_b32 s70, -1
    s_mov_b64 exec, s[86:87]
    v_mov_b32 v30, 0
    v_mov_b32 v31, 0
    s_mov_b64 exec, -1
    v_mov_b32 v4, 0xff800000
    s_lshl_b32 s60, s58, 18
    s_add_u32 s60, s60, 2097152
    s_mov_b32 s61, 0
L_fb1:
    buffer_load_dwordx4 v[128:131], v2, s[32:35], s60 offen sc1
    buffer_load_dwordx4 v[132:135], v2, s[32:35], s60 offen offset:1024 sc1
    s_waitcnt vmcnt(0)
    v_mfma_f32_32x32x16_bf16 v[64:79], v[128:131], v[24:27], 0
    v_mfma_f32_32x32x16_bf16 v[64:79], v[132:135], v[28:31], v[64:79]
    s_nop 11
    v_max3_f32 v4, v4, v64, v65
    v_max3_f32 v4, v4, v66, v67
    v_max3_f32 v4, v4, v68, v69
    v_max3_f32 v4, v4, v70, v71
    v_max3_f32 v4, v4, v72, v73
    v_max3_f32 v4, v4, v74, v75
    v_max3_f32 v4, v4, v76, v77
    v_max3_f32 v4, v4, v78, v79
    s_add_u32 s60, s60, 4096
    s_add_u32 s61, s61, 1
    s_cmp_lt_u32 s61, 64
    s_cbranch_scc1 L_fb1
    v_mov_b32 v5, v4
    s_nop 1
    v_permlane32_swap_b32 v4, v5
    v_max_f32 v4, v4, v5
    v_sub_f32 v4, 0, v4
    v_and_b32 v5, 0xffff0000, v4
    v_sub_f32 v4, v4, v5
    v_lshrrev_b32 v5, 16, v5
    v_and_b32 v6, 0xffff0000, v4
    v_sub_f32 v4, v4, v6
    s_mov_b64 exec, s[86:87]
    v_or_b32 v30, v5, v6
    v_lshrrev_b32 v31, 16, v4
    s_mov_b64 exec, -1
    v_mov_b32 v224, 0
    v_mov_b32 v225, 0
    v_mov_b32 v226, 0
    v_mov_b32 v227, 0
    v_mov_b32 v228, 0
    v_mov_b32 v229, 0
    v_mov_b32 v230, 0
    v_mov_b32 v231, 0
    v_mov_b32 v232, 0
    v_mov_b32 v233, 0
    v_mov_b32 v234, 0
    v_mov_b32 v235, 0
    v_mov_b32 v236, 0
    v_mov_b32 v237, 0
    v_mov_b32 v238, 0
    v_mov_b32 v239, 0
    s_lshl_b32 s60, s58, 18
    s_add_u32 s60, s60, 2097152
    s_mov_b32 s61, 0
L_fb2:
    buffer_load_dwordx4 v[128:131], v2, s[32:35], s60 offen offset:0 sc1
    buffer_load_dwordx4 v[132:135], v2, s[32:35], s60 offen offset:1024 sc1
    buffer_load_dwordx4 v[136:139], v2, s[32:35], s60 offen offset:2048 sc1
    buffer_load_dwordx4 v[140:143], v2, s[32:35], s60 offen offset:3072 sc1
    s_waitcnt vmcnt(0)
    v_mfma_f32_32x32x16_bf16 v[64:79], v[128:131], v[24:27], 0
    v_mfma_f32_32x32x16_bf16 v[64:79], v[132:135], v[28:31], v[64:79]
    s_nop 11
    v_exp_f32 v112, v64
    v_exp_f32 v113, v65
    v_exp_f32 v114, v66
    v_exp_f32 v115, v67
    v_exp_f32 v116, v68
    v_exp_f32 v117, v69
    v_exp_f32 v118, v70
    v_exp_f32 v119, v71
    v_exp_f32 v120, v72
    v_exp_f32 v121, v73
    v_exp_f32 v122, v74
    v_exp_f32 v123, v75
    v_exp_f32 v124, v76
    v_exp_f32 v125, v77
    v_exp_f32 v126, v78
    v_exp_f32 v127, v79
    v_smfmac_f32_32x32x32_bf16 v[224:239], v[136:139], v[112:119], v176
    s_nop 0
    v_smfmac_f32_32x32x32_bf16 v[224:239], v[140:143], v[120:127], v176
    s_add_u32 s60, s60, 4096
    s_add_u32 s61, s61, 1
    s_cmp_lt_u32 s61, 64
    s_cbranch_scc1 L_fb2
    s_nop 11
    s_branch L_final
L_end:
    s_endpgm
.section .rodata,"a"
.p2align 6
.amdhsa_kernel concat_heads__softmax_full_mha__linear_kernel_hedgehog__prompt_kernel
  .amdhsa_next_free_vgpr 248
  .amdhsa_next_free_sgpr 102
  .amdhsa_accum_offset 248
  .amdhsa_group_segment_fixed_size 0
  .amdhsa_kernarg_size 80
  .amdhsa_user_sgpr_count 2
  .amdhsa_user_sgpr_kernarg_segment_ptr 1
  .amdhsa_system_sgpr_workgroup_id_x 1
.end_amdhsa_kernel
```
